```python
import torch

def _softmax(x, axis=-1):
    return torch.softmax(x, dim=axis)

def _gelu(x):
    return torch.nn.functional.gelu(x, approximate='tanh')

def _silu(x):
    return torch.nn.functional.silu(x)

def _sigmoid(x):
    return torch.sigmoid(x)

def _layernorm(x, axis=-1, eps=1e-05):
    m = x.mean(dim=axis, keepdim=True)
    v = x.var(dim=axis, keepdim=True, unbiased=False)
    return (x - m) / torch.sqrt(v + eps)

def _scatter_add(tgt, idx, src, axis=0):
    return tgt.clone().index_add_(axis, idx, src)

def _segment_sum(src, seg, n):
    out = torch.zeros((n,) + src.shape[1:], dtype=src.dtype)
    return out.index_add_(0, seg, src)

def _pad(x, pw):
    flat = tuple((v for pair in reversed(pw) for v in pair))
    return torch.nn.functional.pad(x, flat)
kernel_name = 'adaLN_cond__ssm_conv_s4d__swiglu_ffn__prompt'

def setup_inputs():

    _w = lambda a: (lambda t: t.to(torch.bfloat16) if t.is_floating_point() else t)(torch.as_tensor(a))

    def _A_setup():
        Bsz, L, D, N = (1, 2048, 512, 128)
        return {'u': _w((lambda *s: torch.randn(*s, dtype=torch.bfloat16) * 0.05)(Bsz, L, D)), 'log_A_real': _w((lambda *s: torch.randn(*s, dtype=torch.bfloat16) * 3.2)(D, N) * 0.5), 'A_imag': _w((lambda *s: torch.randn(*s, dtype=torch.bfloat16) * 0.1)(D, N) * 3.14), 'C_real': _w((lambda *s: torch.randn(*s, dtype=torch.bfloat16) * 0.4)(D, N) / N ** 0.5), 'C_imag': _w((lambda *s: torch.randn(*s, dtype=torch.bfloat16) * 0.4)(D, N) / N ** 0.5), 'log_dt': _w((lambda *s: torch.randn(*s, dtype=torch.bfloat16) * 0.1)(D) * 0.5 - 4.0), 'D_skip': _w((lambda *s: torch.randn(*s, dtype=torch.bfloat16) * 0.1)(D))}
    _A_in = _A_setup()

    def _B_setup():
        B, S, D, F = (1, 2048, 512, 1792)
        return {'x': _w((lambda *s: torch.randn(*s, dtype=torch.bfloat16) * 0.05)(B, S, D)), 'w_gate': _w((lambda *s: torch.randn(*s, dtype=torch.bfloat16) * 0.05)(D, F)), 'w_up': _w((lambda *s: torch.randn(*s, dtype=torch.bfloat16) * 0.05)(D, F)), 'w_down': _w((lambda *s: torch.randn(*s, dtype=torch.bfloat16) * 0.05)(F, D))}
    _B_in = _B_setup()
    return {'A_u': _A_in['u'], 'A_log_A_real': _A_in['log_A_real'], 'A_A_imag': _A_in['A_imag'], 'A_C_real': _A_in['C_real'], 'A_C_imag': _A_in['C_imag'], 'A_log_dt': _A_in['log_dt'], 'A_D_skip': _A_in['D_skip'], 'B_x': _B_in['x'], 'B_w_gate': _B_in['w_gate'], 'B_w_up': _B_in['w_up'], 'B_w_down': _B_in['w_down'], 'c': _w((lambda *s: torch.randn(*s, dtype=torch.bfloat16) * 0.2)(1, 512) * 8.0), 'w_mod': _w((lambda *s: torch.randn(*s, dtype=torch.bfloat16) * 0.2)(512, 6 * 512) * 512 ** (-0.5) * 8.0)}

def reference(A_u, A_log_A_real, A_A_imag, A_C_real, A_C_imag, A_log_dt, A_D_skip, B_x, B_w_gate, B_w_up, B_w_down, c, w_mod):

    def _A_ref(u, log_A_real, A_imag, C_real, C_imag, log_dt, D_skip):
        L = u.shape[1]
        dt = torch.exp(log_dt)
        A = -torch.exp(log_A_real) + 1j * A_imag
        C = (C_real + 1j * C_imag) * dt[:, None]
        pos = (lambda x, dt: x.to(dt))(torch.arange(L), log_dt.dtype)
        P = torch.exp((A * dt[:, None])[:, :, None] * pos[None, None, :])
        K = 2.0 * torch.einsum('dn,dnl->dl', C, P).real
        L2 = 2 * L
        u_t = (lambda x, *d: x.permute(*d))(u, 0, 2, 1)
        Kf = (lambda x, *a, **k: torch.fft.rfft(x.float(), *a, **k))(K, L2)
        Uf = (lambda x, *a, **k: torch.fft.rfft(x.float(), *a, **k))(u_t, L2)
        y = (lambda x, *a, **k: torch.fft.irfft(x, *a, **k).to(torch.bfloat16))(Uf * Kf[None, :, :], L2)[:, :, :L]
        y = (lambda x, *d: x.permute(*d))(y, 0, 2, 1)
        return y + u * D_skip[None, None, :]

    def _B_ref(x, w_gate, w_up, w_down):
        g = _silu(x @ w_gate)
        u = x @ w_up
        return g * u @ w_down
    x = A_u
    mod = (_silu(c) @ w_mod).reshape(c.shape[0], 6, 1, -1)
    sa, ca, ga, sb, cb, gb = (mod[:, 0].clone(), mod[:, 1].clone(), mod[:, 2].clone(), mod[:, 3].clone(), mod[:, 4].clone(), mod[:, 5].clone())
    h = _layernorm(x, axis=-1) * (1 + ca) + sa
    x = x + ga * _A_ref(h, A_log_A_real, A_A_imag, A_C_real, A_C_imag, A_log_dt, A_D_skip)
    h = _layernorm(x, axis=-1) * (1 + cb) + sb
    x = x + gb * _B_ref(h, B_w_gate, B_w_up, B_w_down)
    return x
```

```asm
; @launch grid=(256,1,1) block=(256,1,1) lds=163840
.amdgcn_target "amdgcn-amd-amdhsa--gfx950"
.text
.globl adaLN_cond__ssm_conv_s4d__swiglu_ffn__prompt_kernel
.p2align 8
.type adaLN_cond__ssm_conv_s4d__swiglu_ffn__prompt_kernel,@function
adaLN_cond__ssm_conv_s4d__swiglu_ffn__prompt_kernel:
    s_cmp_ge_u32 s2, 256
    s_cbranch_scc1 Lend
    s_load_dwordx16 s[8:23], s[0:1], 0
    s_load_dwordx16 s[24:39], s[0:1], 64
    v_lshlrev_b32 v1, 4, v0
    s_getpc_b64 s[92:93]
Lpc:
    s_sub_u32 s92, s92, Lpc-adaLN_cond__ssm_conv_s4d__swiglu_ffn__prompt_kernel
    s_subb_u32 s93, s93, 0
    s_mov_b32 s94, Lend-adaLN_cond__ssm_conv_s4d__swiglu_ffn__prompt_kernel
    s_mov_b32 s95, 0x00020000
    s_bfe_u32 s68, s2, 196611
    s_lshl_b32 s68, s68, 12
    buffer_load_dwordx4 v[144:147], v1, s[92:95], s68 offen
    v_lshrrev_b32 v5, 6, v0
    v_lshrrev_b32 v72, 3, v0
    v_and_b32 v223, 7, v0
    v_readfirstlane_b32 s3, v5
    v_lshlrev_b32 v1, 4, v0
    v_and_b32 v2, 0x3f0, v1
    v_lshlrev_b32 v5, 4, v223
    v_lshl_add_u32 v80, v72, 10, v5
    s_movk_i32 s4, 6144
    v_mad_u32_u24 v81, v72, s4, v5
    v_lshlrev_b32 v83, 2, v0
    s_bfe_u32 s69, s2, 0x20001
    s_and_b32 s4, s2, 1
    s_mul_i32 s4, s4, 24
    s_lshr_b32 s70, s2, 3
    s_add_u32 s70, s70, s4
    s_lshl_b32 s4, s69, 8
    v_lshl_add_u32 v82, v72, 1, s4
    s_lshl_b32 s4, s2, 9
    v_lshl_add_u32 v84, v0, 1, s4
    v_mov_b32 v6, 1073741824
    v_cmp_eq_u32 vcc, 0, v0
    v_mov_b32 v85, 0
    s_cmp_lt_u32 s2, 224
    s_cselect_b32 s64, 0, 1073741824
    s_cselect_b32 s54, 1835008, 0
    s_cselect_b32 s58, 1835008, 0
    v_cndmask_b32 v3, v6, v0, vcc
    v_cmp_gt_u32 vcc, 8, v0
    v_lshlrev_b32 v7, 12, v0
    s_cmp_lt_u32 s2, 192
    s_cselect_b32 s50, 3145728, 0
    s_cselect_b32 s4, 1073741824, 0
    v_cndmask_b32 v4, v6, v7, vcc
    v_or_b32 v86, s4, v4
    s_lshr_b32 s4, s2, 4
    s_lshl_b32 s4, s4, 15
    s_and_b32 s86, s2, 15
    s_lshl_b32 s86, s86, 8
    s_add_u32 s86, s86, s4
    s_add_u32 s86, s86, 0
    s_mov_b32 s42, 0x10000000
    s_mov_b32 s46, 2097152
    s_mov_b32 s43, 0x00020000
    s_mov_b32 s47, 0x00020000
    s_mov_b32 s51, 0x00020000
    s_mov_b32 s55, 0x00020000
    s_lshr_b32 s4, s2, 6
    s_lshl_b32 s4, s4, 3
    s_and_b32 s5, s2, 7
    s_add_u32 s84, s4, s5
    s_lshl_b32 s4, s84, 16
    s_bfe_u32 s85, s2, 0x30003
    s_lshl_b32 s5, s85, 7
    s_add_u32 s4, s4, s5
    s_add_u32 s5, s4, 32768
    s_lshl_b32 s6, s84, 3
    s_add_u32 s6, s6, s85
    s_lshl_b32 s6, s6, 13
    s_add_u32 s7, s6, 4096
    s_waitcnt lgkmcnt(0)
    s_mov_b64 s[44:45], s[8:9]
    s_mov_b64 s[40:41], s[38:39]
    buffer_store_dword v85, v86, s[40:43], s86 offen sc1
    buffer_load_dwordx4 v[8:11], v80, s[44:47], s4 offen nt
    buffer_load_dwordx4 v[12:15], v80, s[44:47], s5 offen nt
    buffer_load_dwordx4 v[16:19], v1, s[44:47], s6 offen nt
    buffer_load_dwordx4 v[20:23], v1, s[44:47], s7 offen nt
    s_lshl_b32 s4, s2, 2
    v_lshrrev_b32 v5, 7, v0
    v_lshl_add_u32 v86, v5, 1, s4
    v_mov_b32 v87, s4
    global_load_ushort v52, v84, s[10:11] nt
    global_load_ushort v53, v84, s[12:13] nt
    global_load_ushort v54, v84, s[14:15] nt
    global_load_ushort v55, v84, s[16:17] nt
    global_load_ushort v76, v86, s[18:19]
    global_load_dword v77, v87, s[20:21]
    global_load_ushort v40, v82, s[30:31] offset:0
    global_load_ushort v41, v82, s[30:31] offset:64
    global_load_ushort v42, v82, s[30:31] offset:128
    global_load_ushort v43, v82, s[30:31] offset:192
    s_mov_b64 s[48:49], s[32:33]
    s_mul_i32 s4, s69, 786432
    s_lshl_b32 s5, s70, 7
    s_add_u32 s4, s4, s5
    buffer_load_dwordx4 v[24:27], v81, s[48:51], s4 offen nt
    s_add_u32 s4, s4, 196608
    buffer_load_dwordx4 v[28:31], v81, s[48:51], s4 offen nt
    s_add_u32 s4, s4, 196608
    buffer_load_dwordx4 v[32:35], v81, s[48:51], s4 offen nt
    s_add_u32 s4, s4, 196608
    buffer_load_dwordx4 v[36:39], v81, s[48:51], s4 offen nt
    s_mov_b64 s[52:53], s[28:29]
    s_lshl_b32 s67, s2, 13
    s_and_b32 s4, s2, 7
    s_mul_i32 s4, s4, 7
    s_lshr_b32 s5, s2, 5
    s_add_u32 s4, s4, s5
    s_and_b32 s66, s4, 1
    s_lshr_b32 s4, s4, 1
    s_lshl_b32 s4, s4, 2
    s_bfe_u32 s5, s2, 0x20003
    s_add_u32 s65, s4, s5
    s_cmp_eq_u32 s66, 0
    s_cselect_b64 s[56:57], s[24:25], s[26:27]
    s_mov_b64 s[60:61], s[34:35]
    s_mov_b64 s[88:89], s[36:37]
    s_mov_b32 s62, 2097152
    s_mov_b32 s90, 256
    s_mov_b32 s59, 0x00020000
    s_mov_b32 s63, 0x00020000
    s_mov_b32 s91, 0x00020000
    s_mov_b32 s71, 0x05040100
    s_mov_b32 s72, 0x07060302
    s_mov_b32 s73, 0x3f803f80
    s_mov_b32 s87, 0xffff0000
    s_lshl_b32 s29, s65, 5
    s_movk_i32 s4, 28672
    v_lshlrev_b32 v5, 2, v223
    v_mad_u32_u24 v78, v72, s4, v5
    v_lshrrev_b32 v5, 5, v0
    v_xor_b32 v5, v5, v223
    v_lshlrev_b32 v5, 4, v5
    v_lshl_add_u32 v5, v223, 10, v5
    v_and_b32 v6, 3, v72
    v_lshl_add_u32 v208, v6, 2, v5
    v_lshrrev_b32 v5, 5, v2
    v_and_b32 v6, 16, v5
    s_lshl_b32 s4, s3, 2
    s_add_u32 s4, s4, 8192
    v_add_u32 v209, s4, v6
    v_and_b32 v5, 24, v5
    v_lshl_add_u32 v5, v223, 5, v5
    s_lshl_b32 s4, s3, 8
    s_add_u32 s4, s4, 8448
    v_add_u32 v210, s4, v5
    v_lshrrev_b32 v5, 4, v0
    v_and_b32 v6, 0xf0, v1
    s_mov_b32 s4, 114688
    v_mad_u32_u24 v211, v5, s4, v6
    v_add_u32 v211, s64, v211
    s_lshl_b32 s28, s2, 9
    s_add_u32 s28, s28, 12582912
    s_movk_i32 s4, 8448
    v_mad_u32_u24 v212, v5, s4, v6
    s_lshl_b32 s4, s3, 4
    v_xor_b32 v6, s4, v6
    v_lshl_add_u32 v213, v5, 8, v6
    v_xor_b32 v214, 64, v213
    v_cmp_gt_u32 vcc, 16, v0
    v_mov_b32 v5, 1073741824
    v_and_b32 v74, 0xff, v1
    v_cndmask_b32 v215, v5, v1, vcc
    v_cmp_gt_u32 vcc, 4, v0
    v_lshrrev_b32 v6, 1, v0
    v_lshlrev_b32 v6, 13, v6
    v_and_b32 v73, 16, v1
    v_add_u32 v6, v6, v73
    v_cndmask_b32 v73, v5, v6, vcc
    s_mul_i32 s4, s85, 270336
    s_lshl_b32 s5, s84, 8
    s_add_u32 s4, s4, s5
    s_add_u32 s24, s4, 1048576
    s_add_u32 s25, s24, 135168
    s_lshr_b32 s26, s6, 8
    s_add_u32 s26, s26, 65536
    s_mul_i32 s4, s69, 12288
    s_lshl_b32 s5, s70, 8
    s_add_u32 s4, s4, s5
    s_add_u32 s27, s4, 131072
    s_cmp_lt_u32 s2, 192
    s_cselect_b32 s4, 0, 1073741824
    v_or_b32 v215, s4, v215
    s_and_b32 s30, s2, 15
    s_lshr_b32 s4, s3, 1
    s_mul_i32 s5, s4, 29056
    s_add_u32 s5, s5, 24576
    v_lshl_add_u32 v79, v0, 2, s5
    v_bfe_u32 v5, v0, 0, 4
    v_bfe_u32 v6, v0, 4, 2
    s_mul_i32 s5, s4, 29568
    s_add_u32 s5, s5, 24576
    s_movk_i32 s6, 528
    v_lshl_add_u32 v7, v6, 4, s5
    v_mad_u32_u24 v184, v5, s6, v7
    s_and_b32 s6, s3, 1
    s_mul_i32 s5, s6, 8448
    s_add_u32 s5, s5, 12672
    v_add_u32 v185, s5, v184
    s_mul_i32 s5, s4, 5120
    s_lshl_b32 s6, s6, 8
    s_add_u32 s5, s5, s6
    s_add_u32 s5, s5, 14336
    v_lshl_add_u32 v5, v5, 4, s5
    s_movk_i32 s5, 0x0202
    v_mov_b32 v7, 0x0c0c0100
    v_mad_u32_u24 v6, v6, s5, v7
    v_mov_b32 v7, 524288
    s_mov_b32 s5, 67109376
    v_perm_b32 v186, s5, v7, v6
    v_mov_b32 v7, 131074
    s_mov_b32 s5, 33554436
    v_perm_b32 v187, s5, v7, v6
    v_mov_b32 v7, 201327624
    s_mov_b32 s5, 134612994
    v_perm_b32 v188, s5, v7, v6
    v_add_u32 v186, v186, v5
    v_add_u32 v188, v188, v5
    v_add_u32 v189, v186, v187
    v_add_u32 v190, v189, v187
    v_add_u32 v191, v190, v187
    v_and_b32 v5, 127, v0
    s_mul_i32 s5, s4, 5120
    s_add_u32 s5, s5, 14336
    v_lshl_add_u32 v194, v5, 2, s5
    v_add_u32 v193, 2, v194
    v_add_u32 v192, 4, v194
    v_bfe_u32 v6, v192, 2, 1
    v_lshl_add_u32 v6, v6, 1, v192
    v_add_u32 v6, 0, v6
    v_and_b32 v195, -4, v6
    v_bfe_u32 v6, v193, 2, 1
    v_lshl_add_u32 v6, v6, 1, v193
    v_add_u32 v6, 0, v6
    v_and_b32 v196, -4, v6
    v_bfe_u32 v6, v194, 2, 1
    v_lshl_add_u32 v6, v6, 1, v194
    v_add_u32 v6, 0, v6
    v_and_b32 v197, -4, v6
    v_bfe_u32 v6, v192, 3, 1
    v_lshl_add_u32 v6, v6, 1, v192
    v_add_u32 v6, 2, v6
    v_and_b32 v198, -8, v6
    v_bfe_u32 v6, v193, 3, 1
    v_lshl_add_u32 v6, v6, 1, v193
    v_add_u32 v6, 2, v6
    v_and_b32 v199, -8, v6
    v_bfe_u32 v6, v194, 3, 1
    v_lshl_add_u32 v6, v6, 1, v194
    v_add_u32 v6, 2, v6
    v_and_b32 v200, -8, v6
    v_bfe_u32 v6, v192, 4, 1
    v_lshl_add_u32 v6, v6, 1, v192
    v_add_u32 v6, 6, v6
    v_and_b32 v201, -16, v6
    v_bfe_u32 v6, v193, 4, 1
    v_lshl_add_u32 v6, v6, 1, v193
    v_add_u32 v6, 6, v6
    v_and_b32 v202, -16, v6
    v_bfe_u32 v6, v194, 4, 1
    v_lshl_add_u32 v6, v6, 1, v194
    v_add_u32 v6, 6, v6
    v_and_b32 v203, -16, v6
    s_mul_i32 s6, s4, 8320
    s_add_u32 s6, s6, 108028
    v_lshlrev_b32 v6, 2, v5
    v_sub_u32 v204, s6, v6
    s_mul_i32 s7, s4, 4608
    s_add_u32 s7, s7, 98304
    v_add_u32 v205, s7, v6
    v_and_b32 v6, 28, v6
    v_bfe_u32 v7, v0, 3, 1
    s_movk_i32 s7, 4160
    v_mad_u32_u24 v6, v7, s7, v6
    s_add_u32 s6, s6, 3588
    v_add_u32 v206, s6, v6
    v_mov_b32 v207, s5
    v_mov_b32 v7, 0
    v_mov_b32 v5, 0x3f80
    ds_write_b32 v205, v7
    ds_write_b32 v79, v5 offset:12672
    s_add_u32 s7, s67, 4096
    buffer_load_dword v176, v83, s[52:55], s67 offen offset:0 nt
    buffer_load_dword v177, v83, s[52:55], s67 offen offset:1024 nt
    buffer_load_dword v178, v83, s[52:55], s67 offen offset:2048 nt
    buffer_load_dword v179, v83, s[52:55], s67 offen offset:3072 nt
    buffer_load_dword v180, v83, s[52:55], s7 offen offset:0 nt
    buffer_load_dword v181, v83, s[52:55], s7 offen offset:1024 nt
    buffer_load_dword v182, v83, s[52:55], s7 offen offset:2048 nt
    buffer_load_dword v183, v83, s[52:55], s7 offen offset:3072 nt
    s_cmp_ge_u32 s2, 240
    s_cselect_b32 s4, 0, 1073741824
    s_lshl_b32 s5, s30, 2
    v_or_b32 v5, s4, v3
    v_mov_b32 v6, 1
    s_waitcnt vmcnt(26)
    buffer_store_dword v6, v5, s[88:91], s5 offen offset:128 sc1
    s_waitcnt vmcnt(25)
    ds_write2_b32 v208, v8, v12 offset0:0 offset1:32
    ds_write2_b32 v208, v9, v13 offset0:64 offset1:96
    ds_write2_b32 v208, v10, v14 offset0:128 offset1:160
    ds_write2_b32 v208, v11, v15 offset0:192 offset1:224
    s_waitcnt vmcnt(23)
    v_dot2_f32_bf16 v80, v16, s73, 0
    v_dot2_f32_bf16 v81, v16, v16, 0
    v_dot2_f32_bf16 v82, v20, s73, 0
    v_dot2_f32_bf16 v83, v20, v20, 0
    v_dot2_f32_bf16 v80, v17, s73, v80
    v_dot2_f32_bf16 v81, v17, v17, v81
    v_dot2_f32_bf16 v82, v21, s73, v82
    v_dot2_f32_bf16 v83, v21, v21, v83
    v_dot2_f32_bf16 v80, v18, s73, v80
    v_dot2_f32_bf16 v81, v18, v18, v81
    v_dot2_f32_bf16 v82, v22, s73, v82
    v_dot2_f32_bf16 v83, v22, v22, v83
    v_dot2_f32_bf16 v80, v19, s73, v80
    v_dot2_f32_bf16 v81, v19, v19, v81
    v_dot2_f32_bf16 v82, v23, s73, v82
    v_dot2_f32_bf16 v83, v23, v23, v83
    s_nop 1
    v_permlane32_swap_b32 v80, v82
    v_permlane32_swap_b32 v81, v83
    v_add_f32 v80, v80, v82
    v_add_f32 v81, v81, v83
    s_nop 1
    v_permlane16_swap_b32 v80, v81
    v_add_f32 v80, v80, v81
    s_nop 1
    v_add_f32_dpp v80, v80, v80 row_ror:8 row_mask:0xf bank_mask:0xf
    s_nop 1
    v_add_f32_dpp v80, v80, v80 row_ror:4 row_mask:0xf bank_mask:0xf
    s_nop 1
    v_add_f32_dpp v80, v80, v80 row_ror:2 row_mask:0xf bank_mask:0xf
    s_nop 1
    v_add_f32_dpp v80, v80, v80 row_ror:1 row_mask:0xf bank_mask:0xf
    v_mov_b32 v81, v80
    s_mov_b32 s5, 0x3b000000
    s_nop 0
    v_permlane16_swap_b32 v80, v81
    v_mul_f32 v80, s5, v80
    v_mul_f32 v82, v80, v80
    v_fma_f32 v81, v81, s5, -v82
    v_add_f32 v81, 0x3727c5ac, v81
    v_rsq_f32 v81, v81
    s_nop 0
    v_mul_f32 v80, -v80, v81
    ds_write2_b32 v209, v81, v80 offset0:0 offset1:8
    s_waitcnt lgkmcnt(0)
    s_barrier
    ds_read_b128 v[8:11], v213 offset:0
    ds_read_b128 v[12:15], v214 offset:4096
    ds_read_b128 v[16:19], v74 offset:8192
    s_waitcnt vmcnt(13)
    v_lshlrev_b32 v40, 16, v40
    v_lshlrev_b32 v41, 16, v41
    v_lshlrev_b32 v42, 16, v42
    v_lshlrev_b32 v43, 16, v43
    v_mul_f32 v84, 0xbfb8aa3b, v40
    v_mul_f32 v85, 0xbfb8aa3b, v41
    v_mul_f32 v86, 0xbfb8aa3b, v42
    v_mul_f32 v87, 0xbfb8aa3b, v43
    v_exp_f32 v84, v84
    v_exp_f32 v85, v85
    v_exp_f32 v86, v86
    v_exp_f32 v87, v87
    s_waitcnt lgkmcnt(2)
    buffer_store_dwordx4 v[8:11], v212, s[40:43], s24 offen sc1
    v_add_f32 v84, 1.0, v84
    v_add_f32 v85, 1.0, v85
    v_add_f32 v86, 1.0, v86
    v_add_f32 v87, 1.0, v87
    s_waitcnt lgkmcnt(1)
    buffer_store_dwordx4 v[12:15], v212, s[40:43], s25 offen sc1
    v_rcp_f32 v84, v84
    v_rcp_f32 v85, v85
    v_rcp_f32 v86, v86
    v_rcp_f32 v87, v87
    s_waitcnt lgkmcnt(0)
    buffer_store_dwordx4 v[16:19], v73, s[40:43], s26 offen sc1
    v_mov_b32 v248, 0
    s_lshl_b32 s4, s2, 8
    s_add_u32 s4, s4, 3670016
    buffer_store_dword v248, v3, s[40:43], s4 offen sc1
    v_mul_f32 v84, v84, v40
    v_mul_f32 v85, v85, v41
    v_mul_f32 v86, v86, v42
    v_mul_f32 v87, v87, v43
    v_cvt_pk_bf16_f32 v40, v84, v85
    v_cvt_pk_bf16_f32 v41, v86, v87
    v_lshlrev_b32 v76, 16, v76
    v_lshlrev_b32 v52, 16, v52
    v_lshlrev_b32 v53, 16, v53
    v_lshlrev_b32 v54, 16, v54
    v_lshlrev_b32 v55, 16, v55
    v_readfirstlane_b32 s68, v77
    v_mul_f32 v5, 0x3fb8aa3b, v76
    s_mov_b32 s4, 0x3fb8aa3b
    v_fma_f32 v80, v76, s4, -v5
    v_fmamk_f32 v80, v76, 0x32a57060, v80
    v_exp_f32 v5, v5
    v_mul_f32 v80, 0x3f317218, v80
    v_fma_f32 v5, v5, v80, v5
    v_cvt_pk_bf16_f32 v5, v5, v5
    v_lshlrev_b32 v76, 16, v5
    v_mul_f32 v6, 0x3fb8aa3b, v52
    s_mov_b32 s4, 0x3fb8aa3b
    v_fma_f32 v7, v52, s4, -v6
    v_fmamk_f32 v7, v52, 0x32a57060, v7
    v_exp_f32 v6, v6
    v_mul_f32 v7, 0x3f317218, v7
    v_fma_f32 v6, v6, v7, v6
    v_cvt_pk_bf16_f32 v6, v6, v6
    v_lshlrev_b32 v52, 16, v6
    s_lshl_b32 s16, s68, 16
    s_and_b32 s17, s68, s87
    v_mul_f32 v81, -v52, v76
    v_mul_f32 v82, v53, v76
    v_mul_f32 v94, v54, v76
    v_mul_f32 v95, v55, v76
    v_mul_f32 v81, 0x3fb8aa3b, v81
    v_mul_f32 v82, 0x3e22f983, v82
    v_pk_add_f32 v[94:95], v[94:95], v[94:95]
    v_mul_f32 v132, 0x41000000, v81
    v_mul_f32 v133, 0x41000000, v82
    v_exp_f32 v132, v132
    v_fract_f32 v133, v133
    v_cos_f32 v86, v133
    v_sin_f32 v87, v133
    v_mul_f32 v130, 0x3f800000, v81
    v_mul_f32 v131, 0x3f800000, v82
    v_exp_f32 v130, v130
    v_fract_f32 v131, v131
    v_cos_f32 v84, v131
    v_sin_f32 v85, v131
    v_mul_f32 v134, 0x43800000, v81
    v_mul_f32 v135, 0x43800000, v82
    v_exp_f32 v134, v134
    v_fract_f32 v135, v135
    v_cos_f32 v88, v135
    v_sin_f32 v89, v135
    v_pk_mul_f32 v[86:87], v[86:87], v[132:133] op_sel:[0,0] op_sel_hi:[1,0]
    v_pk_mul_f32 v[84:85], v[84:85], v[130:131] op_sel:[0,0] op_sel_hi:[1,0]
    v_pk_mul_f32 v[88:89], v[88:89], v[134:135] op_sel:[0,0] op_sel_hi:[1,0]
    v_pk_mul_f32 v[122:123], v[86:87], v[86:87] op_sel:[0,0] op_sel_hi:[0,1]
    v_pk_mul_f32 v[90:91], v[84:85], v[84:85] op_sel:[0,0] op_sel_hi:[0,1]
    v_pk_mul_f32 v[96:97], v[94:95], v[84:85] op_sel:[0,0] op_sel_hi:[0,1]
    v_pk_mul_f32 v[110:111], v[94:95], v[88:89] op_sel:[0,0] op_sel_hi:[0,1]
    v_pk_fma_f32 v[122:123], v[86:87], v[86:87], v[122:123] op_sel:[1,1,0] op_sel_hi:[1,0,1] neg_lo:[0,1,0]
    v_pk_fma_f32 v[90:91], v[84:85], v[84:85], v[90:91] op_sel:[1,1,0] op_sel_hi:[1,0,1] neg_lo:[0,1,0]
    v_pk_fma_f32 v[96:97], v[94:95], v[84:85], v[96:97] op_sel:[1,1,0] op_sel_hi:[1,0,1] neg_lo:[0,1,0]
    v_pk_fma_f32 v[110:111], v[94:95], v[88:89], v[110:111] op_sel:[1,1,0] op_sel_hi:[1,0,1] neg_lo:[0,1,0]
    v_cvt_pk_bf16_f32 v126, v86, v87
    ds_write_b32 v79, v126 offset:13200
    v_cvt_pk_bf16_f32 v127, v94, -v95
    ds_write_b32 v79, v127 offset:0
    v_pk_mul_f32 v[124:125], v[122:123], v[86:87] op_sel:[0,0] op_sel_hi:[0,1]
    v_pk_mul_f32 v[92:93], v[122:123], v[122:123] op_sel:[0,0] op_sel_hi:[0,1]
    v_pk_mul_f32 v[98:99], v[94:95], v[90:91] op_sel:[0,0] op_sel_hi:[0,1]
    v_pk_mul_f32 v[100:101], v[96:97], v[90:91] op_sel:[0,0] op_sel_hi:[0,1]
    v_pk_fma_f32 v[124:125], v[122:123], v[86:87], v[124:125] op_sel:[1,1,0] op_sel_hi:[1,0,1] neg_lo:[0,1,0]
    v_pk_fma_f32 v[92:93], v[122:123], v[122:123], v[92:93] op_sel:[1,1,0] op_sel_hi:[1,0,1] neg_lo:[0,1,0]
    v_pk_fma_f32 v[98:99], v[94:95], v[90:91], v[98:99] op_sel:[1,1,0] op_sel_hi:[1,0,1] neg_lo:[0,1,0]
    v_pk_fma_f32 v[100:101], v[96:97], v[90:91], v[100:101] op_sel:[1,1,0] op_sel_hi:[1,0,1] neg_lo:[0,1,0]
    v_cvt_pk_bf16_f32 v128, v122, v123
    ds_write_b32 v79, v128 offset:13728
    v_cvt_pk_bf16_f32 v129, v96, -v97
    ds_write_b32 v79, v129 offset:528
    v_cvt_pk_bf16_f32 v126, v110, -v111
    ds_write_b32 v79, v126 offset:4224
    v_pk_mul_f32 v[120:121], v[86:87], v[92:93] op_sel:[0,0] op_sel_hi:[0,1]
    v_pk_mul_f32 v[102:103], v[98:99], v[90:91] op_sel:[0,0] op_sel_hi:[0,1]
    v_pk_mul_f32 v[104:105], v[100:101], v[90:91] op_sel:[0,0] op_sel_hi:[0,1]
    v_pk_mul_f32 v[112:113], v[98:99], v[88:89] op_sel:[0,0] op_sel_hi:[0,1]
    v_pk_fma_f32 v[120:121], v[86:87], v[92:93], v[120:121] op_sel:[1,1,0] op_sel_hi:[1,0,1] neg_lo:[0,1,0]
    v_pk_fma_f32 v[102:103], v[98:99], v[90:91], v[102:103] op_sel:[1,1,0] op_sel_hi:[1,0,1] neg_lo:[0,1,0]
    v_pk_fma_f32 v[104:105], v[100:101], v[90:91], v[104:105] op_sel:[1,1,0] op_sel_hi:[1,0,1] neg_lo:[0,1,0]
    v_pk_fma_f32 v[112:113], v[98:99], v[88:89], v[112:113] op_sel:[1,1,0] op_sel_hi:[1,0,1] neg_lo:[0,1,0]
    v_cvt_pk_bf16_f32 v127, v124, v125
    ds_write_b32 v79, v127 offset:14256
    v_cvt_pk_bf16_f32 v128, v92, v93
    ds_write_b32 v79, v128 offset:14784
    v_cvt_pk_bf16_f32 v129, v98, -v99
    ds_write_b32 v79, v129 offset:1056
    v_cvt_pk_bf16_f32 v126, v100, -v101
    ds_write_b32 v79, v126 offset:1584
    v_pk_mul_f32 v[140:141], v[122:123], v[92:93] op_sel:[0,0] op_sel_hi:[0,1]
    v_pk_mul_f32 v[142:143], v[124:125], v[92:93] op_sel:[0,0] op_sel_hi:[0,1]
    v_pk_mul_f32 v[118:119], v[92:93], v[92:93] op_sel:[0,0] op_sel_hi:[0,1]
    v_pk_mul_f32 v[106:107], v[102:103], v[90:91] op_sel:[0,0] op_sel_hi:[0,1]
    v_pk_mul_f32 v[108:109], v[104:105], v[90:91] op_sel:[0,0] op_sel_hi:[0,1]
    v_cvt_pk_bf16_f32 v127, v120, v121
    ds_write_b32 v79, v127 offset:15312
    v_cvt_pk_bf16_f32 v128, v102, -v103
    ds_write_b32 v79, v128 offset:2112
    v_cvt_pk_bf16_f32 v129, v104, -v105
    ds_write_b32 v79, v129 offset:2640
    v_cvt_pk_bf16_f32 v126, v112, -v113
    ds_write_b32 v79, v126 offset:4752
    v_pk_fma_f32 v[140:141], v[122:123], v[92:93], v[140:141] op_sel:[1,1,0] op_sel_hi:[1,0,1] neg_lo:[0,1,0]
    v_pk_fma_f32 v[142:143], v[124:125], v[92:93], v[142:143] op_sel:[1,1,0] op_sel_hi:[1,0,1] neg_lo:[0,1,0]
    v_pk_fma_f32 v[118:119], v[92:93], v[92:93], v[118:119] op_sel:[1,1,0] op_sel_hi:[1,0,1] neg_lo:[0,1,0]
    v_pk_fma_f32 v[106:107], v[102:103], v[90:91], v[106:107] op_sel:[1,1,0] op_sel_hi:[1,0,1] neg_lo:[0,1,0]
    v_pk_fma_f32 v[108:109], v[104:105], v[90:91], v[108:109] op_sel:[1,1,0] op_sel_hi:[1,0,1] neg_lo:[0,1,0]
    s_waitcnt vmcnt(13)
    v_perm_b32 v156, v28, v24, s71
    v_perm_b32 v157, v28, v24, s72
    v_perm_b32 v158, v29, v25, s71
    v_perm_b32 v159, v29, v25, s72
    v_perm_b32 v160, v30, v26, s71
    v_perm_b32 v161, v30, v26, s72
    v_perm_b32 v162, v31, v27, s71
    v_perm_b32 v163, v31, v27, s72
    v_dot2_f32_bf16 v148, v156, v40, 0
    v_dot2_f32_bf16 v149, v157, v40, 0
    v_dot2_f32_bf16 v150, v158, v40, 0
    v_dot2_f32_bf16 v151, v159, v40, 0
    v_dot2_f32_bf16 v152, v160, v40, 0
    v_dot2_f32_bf16 v153, v161, v40, 0
    v_dot2_f32_bf16 v154, v162, v40, 0
    v_dot2_f32_bf16 v155, v163, v40, 0
    v_perm_b32 v156, v36, v32, s71
    v_perm_b32 v157, v36, v32, s72
    v_perm_b32 v158, v37, v33, s71
    v_perm_b32 v159, v37, v33, s72
    v_perm_b32 v160, v38, v34, s71
    v_perm_b32 v161, v38, v34, s72
    v_perm_b32 v162, v39, v35, s71
    v_perm_b32 v163, v39, v35, s72
    v_dot2_f32_bf16 v148, v156, v41, v148
    v_dot2_f32_bf16 v149, v157, v41, v149
    v_dot2_f32_bf16 v150, v158, v41, v150
    v_dot2_f32_bf16 v151, v159, v41, v151
    v_dot2_f32_bf16 v152, v160, v41, v152
    v_dot2_f32_bf16 v153, v161, v41, v153
    v_dot2_f32_bf16 v154, v162, v41, v154
    v_dot2_f32_bf16 v155, v163, v41, v155
    v_permlane32_swap_b32 v148, v152
    v_permlane32_swap_b32 v149, v153
    v_permlane32_swap_b32 v150, v154
    v_permlane32_swap_b32 v151, v155
    v_add_f32 v148, v148, v152
    v_add_f32 v149, v149, v153
    v_add_f32 v150, v150, v154
    v_add_f32 v151, v151, v155
    s_nop 0
    v_permlane16_swap_b32 v148, v150
    v_permlane16_swap_b32 v149, v151
    v_add_f32 v148, v148, v150
    v_add_f32 v149, v149, v151
    s_nop 0
    v_add_f32_dpp v148, v148, v148 row_ror:8 row_mask:0xf bank_mask:0xf
    v_add_f32_dpp v149, v149, v149 row_ror:8 row_mask:0xf bank_mask:0xf
    ds_write_b64 v210, v[148:149]
    s_waitcnt lgkmcnt(0)
    s_barrier
    ds_read_b128 v[24:27], v74 offset:8448
    ds_read_b128 v[28:31], v74 offset:8704
    ds_read_b128 v[32:35], v74 offset:8960
    ds_read_b128 v[36:39], v74 offset:9216
    s_waitcnt vmcnt(5)
    v_perm_b32 v8, v177, v176, s71
    v_perm_b32 v12, v177, v176, s72
    v_perm_b32 v9, v179, v178, s71
    v_perm_b32 v13, v179, v178, s72
    v_perm_b32 v10, v181, v180, s71
    v_perm_b32 v14, v181, v180, s72
    v_perm_b32 v11, v183, v182, s71
    v_perm_b32 v15, v183, v182, s72
    buffer_store_dwordx4 v[8:11], v211, s[40:43], s28 offen sc1
    buffer_store_dwordx4 v[12:15], v211, s[40:43], s28 offen offset:256 sc1
    s_waitcnt lgkmcnt(0)
    v_pk_add_f32 v[24:25], v[24:25], v[28:29]
    v_pk_add_f32 v[32:33], v[32:33], v[36:37]
    v_pk_add_f32 v[26:27], v[26:27], v[30:31]
    v_pk_add_f32 v[34:35], v[34:35], v[38:39]
    v_pk_add_f32 v[24:25], v[24:25], v[32:33]
    v_pk_add_f32 v[26:27], v[26:27], v[34:35]
    buffer_store_dwordx4 v[24:27], v215, s[40:43], s27 offen sc1
    v_lshlrev_b32 v75, 2, v0
    buffer_load_dword v75, v75, s[88:91], 0 offen offset:128 sc1
    v_pk_mul_f32 v[138:139], v[120:121], v[92:93] op_sel:[0,0] op_sel_hi:[0,1]
    v_pk_mul_f32 v[122:123], v[140:141], v[92:93] op_sel:[0,0] op_sel_hi:[0,1]
    v_pk_mul_f32 v[124:125], v[142:143], v[92:93] op_sel:[0,0] op_sel_hi:[0,1]
    v_pk_mul_f32 v[114:115], v[102:103], v[88:89] op_sel:[0,0] op_sel_hi:[0,1]
    v_pk_mul_f32 v[116:117], v[106:107], v[88:89] op_sel:[0,0] op_sel_hi:[0,1]
    v_cvt_pk_bf16_f32 v127, v140, v141
    ds_write_b32 v79, v127 offset:15840
    v_cvt_pk_bf16_f32 v128, v142, v143
    ds_write_b32 v79, v128 offset:16368
    v_cvt_pk_bf16_f32 v129, v118, v119
    ds_write_b32 v79, v129 offset:16896
    v_cvt_pk_bf16_f32 v126, v106, -v107
    ds_write_b32 v79, v126 offset:3168
    v_cvt_pk_bf16_f32 v127, v108, -v109
    ds_write_b32 v79, v127 offset:3696
    v_pk_fma_f32 v[138:139], v[120:121], v[92:93], v[138:139] op_sel:[1,1,0] op_sel_hi:[1,0,1] neg_lo:[0,1,0]
    v_pk_fma_f32 v[122:123], v[140:141], v[92:93], v[122:123] op_sel:[1,1,0] op_sel_hi:[1,0,1] neg_lo:[0,1,0]
    v_pk_fma_f32 v[124:125], v[142:143], v[92:93], v[124:125] op_sel:[1,1,0] op_sel_hi:[1,0,1] neg_lo:[0,1,0]
    v_pk_fma_f32 v[114:115], v[102:103], v[88:89], v[114:115] op_sel:[1,1,0] op_sel_hi:[1,0,1] neg_lo:[0,1,0]
    v_pk_fma_f32 v[116:117], v[106:107], v[88:89], v[116:117] op_sel:[1,1,0] op_sel_hi:[1,0,1] neg_lo:[0,1,0]
    v_pk_mul_f32 v[136:137], v[118:119], v[92:93] op_sel:[0,0] op_sel_hi:[0,1]
    v_pk_mul_f32 v[120:121], v[138:139], v[92:93] op_sel:[0,0] op_sel_hi:[0,1]
    v_pk_mul_f32 v[140:141], v[122:123], v[92:93] op_sel:[0,0] op_sel_hi:[0,1]
    v_pk_mul_f32 v[94:95], v[110:111], v[88:89] op_sel:[0,0] op_sel_hi:[0,1]
    v_cvt_pk_bf16_f32 v128, v138, v139
    ds_write_b32 v79, v128 offset:17424
    v_cvt_pk_bf16_f32 v129, v122, v123
    ds_write_b32 v79, v129 offset:17952
    v_cvt_pk_bf16_f32 v126, v124, v125
    ds_write_b32 v79, v126 offset:18480
    v_cvt_pk_bf16_f32 v127, v114, -v115
    ds_write_b32 v79, v127 offset:5280
    v_cvt_pk_bf16_f32 v128, v116, -v117
    ds_write_b32 v79, v128 offset:5808
    v_pk_fma_f32 v[136:137], v[118:119], v[92:93], v[136:137] op_sel:[1,1,0] op_sel_hi:[1,0,1] neg_lo:[0,1,0]
    v_pk_fma_f32 v[120:121], v[138:139], v[92:93], v[120:121] op_sel:[1,1,0] op_sel_hi:[1,0,1] neg_lo:[0,1,0]
    v_pk_fma_f32 v[140:141], v[122:123], v[92:93], v[140:141] op_sel:[1,1,0] op_sel_hi:[1,0,1] neg_lo:[0,1,0]
    v_pk_fma_f32 v[94:95], v[110:111], v[88:89], v[94:95] op_sel:[1,1,0] op_sel_hi:[1,0,1] neg_lo:[0,1,0]
    v_pk_mul_f32 v[142:143], v[124:125], v[92:93] op_sel:[0,0] op_sel_hi:[0,1]
    v_pk_mul_f32 v[118:119], v[136:137], v[92:93] op_sel:[0,0] op_sel_hi:[0,1]
    v_pk_mul_f32 v[138:139], v[120:121], v[92:93] op_sel:[0,0] op_sel_hi:[0,1]
    v_pk_mul_f32 v[96:97], v[114:115], v[88:89] op_sel:[0,0] op_sel_hi:[0,1]
    v_cvt_pk_bf16_f32 v129, v136, v137
    ds_write_b32 v79, v129 offset:19008
    v_cvt_pk_bf16_f32 v126, v120, v121
    ds_write_b32 v79, v126 offset:19536
    v_cvt_pk_bf16_f32 v127, v140, v141
    ds_write_b32 v79, v127 offset:20064
    v_cvt_pk_bf16_f32 v128, v94, -v95
    ds_write_b32 v79, v128 offset:6336
    v_pk_fma_f32 v[142:143], v[124:125], v[92:93], v[142:143] op_sel:[1,1,0] op_sel_hi:[1,0,1] neg_lo:[0,1,0]
    v_pk_fma_f32 v[118:119], v[136:137], v[92:93], v[118:119] op_sel:[1,1,0] op_sel_hi:[1,0,1] neg_lo:[0,1,0]
    v_pk_fma_f32 v[138:139], v[120:121], v[92:93], v[138:139] op_sel:[1,1,0] op_sel_hi:[1,0,1] neg_lo:[0,1,0]
    v_pk_fma_f32 v[96:97], v[114:115], v[88:89], v[96:97] op_sel:[1,1,0] op_sel_hi:[1,0,1] neg_lo:[0,1,0]
    v_pk_mul_f32 v[122:123], v[140:141], v[92:93] op_sel:[0,0] op_sel_hi:[0,1]
    v_pk_mul_f32 v[124:125], v[142:143], v[92:93] op_sel:[0,0] op_sel_hi:[0,1]
    v_pk_mul_f32 v[136:137], v[118:119], v[92:93] op_sel:[0,0] op_sel_hi:[0,1]
    v_pk_mul_f32 v[98:99], v[94:95], v[88:89] op_sel:[0,0] op_sel_hi:[0,1]
    v_cvt_pk_bf16_f32 v129, v142, v143
    ds_write_b32 v79, v129 offset:20592
    v_cvt_pk_bf16_f32 v126, v118, v119
    ds_write_b32 v79, v126 offset:21120
    v_cvt_pk_bf16_f32 v127, v138, v139
    ds_write_b32 v79, v127 offset:21648
    v_cvt_pk_bf16_f32 v128, v96, -v97
    ds_write_b32 v79, v128 offset:8448
    v_pk_fma_f32 v[122:123], v[140:141], v[92:93], v[122:123] op_sel:[1,1,0] op_sel_hi:[1,0,1] neg_lo:[0,1,0]
    v_pk_fma_f32 v[124:125], v[142:143], v[92:93], v[124:125] op_sel:[1,1,0] op_sel_hi:[1,0,1] neg_lo:[0,1,0]
    v_pk_fma_f32 v[136:137], v[118:119], v[92:93], v[136:137] op_sel:[1,1,0] op_sel_hi:[1,0,1] neg_lo:[0,1,0]
    v_pk_fma_f32 v[98:99], v[94:95], v[88:89], v[98:99] op_sel:[1,1,0] op_sel_hi:[1,0,1] neg_lo:[0,1,0]
    v_pk_mul_f32 v[120:121], v[138:139], v[92:93] op_sel:[0,0] op_sel_hi:[0,1]
    v_pk_mul_f32 v[140:141], v[122:123], v[92:93] op_sel:[0,0] op_sel_hi:[0,1]
    v_pk_mul_f32 v[142:143], v[124:125], v[92:93] op_sel:[0,0] op_sel_hi:[0,1]
    v_pk_mul_f32 v[100:101], v[96:97], v[88:89] op_sel:[0,0] op_sel_hi:[0,1]
    v_cvt_pk_bf16_f32 v129, v122, v123
    ds_write_b32 v79, v129 offset:22176
    v_cvt_pk_bf16_f32 v126, v124, v125
    ds_write_b32 v79, v126 offset:22704
    v_cvt_pk_bf16_f32 v127, v136, v137
    ds_write_b32 v79, v127 offset:23232
    v_cvt_pk_bf16_f32 v128, v98, -v99
    ds_write_b32 v79, v128 offset:6864
    v_pk_fma_f32 v[120:121], v[138:139], v[92:93], v[120:121] op_sel:[1,1,0] op_sel_hi:[1,0,1] neg_lo:[0,1,0]
    v_pk_fma_f32 v[140:141], v[122:123], v[92:93], v[140:141] op_sel:[1,1,0] op_sel_hi:[1,0,1] neg_lo:[0,1,0]
    v_pk_fma_f32 v[142:143], v[124:125], v[92:93], v[142:143] op_sel:[1,1,0] op_sel_hi:[1,0,1] neg_lo:[0,1,0]
    v_pk_fma_f32 v[100:101], v[96:97], v[88:89], v[100:101] op_sel:[1,1,0] op_sel_hi:[1,0,1] neg_lo:[0,1,0]
    v_pk_mul_f32 v[118:119], v[136:137], v[92:93] op_sel:[0,0] op_sel_hi:[0,1]
    v_pk_mul_f32 v[138:139], v[120:121], v[92:93] op_sel:[0,0] op_sel_hi:[0,1]
    v_pk_mul_f32 v[122:123], v[140:141], v[92:93] op_sel:[0,0] op_sel_hi:[0,1]
    v_pk_mul_f32 v[94:95], v[98:99], v[88:89] op_sel:[0,0] op_sel_hi:[0,1]
    v_cvt_pk_bf16_f32 v129, v120, v121
    ds_write_b32 v79, v129 offset:23760
    v_cvt_pk_bf16_f32 v126, v140, v141
    ds_write_b32 v79, v126 offset:24288
    v_cvt_pk_bf16_f32 v127, v142, v143
    ds_write_b32 v79, v127 offset:24816
    v_cvt_pk_bf16_f32 v128, v100, -v101
    ds_write_b32 v79, v128 offset:8976
    v_pk_fma_f32 v[118:119], v[136:137], v[92:93], v[118:119] op_sel:[1,1,0] op_sel_hi:[1,0,1] neg_lo:[0,1,0]
    v_pk_fma_f32 v[138:139], v[120:121], v[92:93], v[138:139] op_sel:[1,1,0] op_sel_hi:[1,0,1] neg_lo:[0,1,0]
    v_pk_fma_f32 v[122:123], v[140:141], v[92:93], v[122:123] op_sel:[1,1,0] op_sel_hi:[1,0,1] neg_lo:[0,1,0]
    v_pk_fma_f32 v[94:95], v[98:99], v[88:89], v[94:95] op_sel:[1,1,0] op_sel_hi:[1,0,1] neg_lo:[0,1,0]
    v_pk_mul_f32 v[124:125], v[142:143], v[92:93] op_sel:[0,0] op_sel_hi:[0,1]
    v_pk_mul_f32 v[136:137], v[118:119], v[92:93] op_sel:[0,0] op_sel_hi:[0,1]
    v_pk_mul_f32 v[120:121], v[138:139], v[92:93] op_sel:[0,0] op_sel_hi:[0,1]
    v_pk_mul_f32 v[98:99], v[94:95], v[88:89] op_sel:[0,0] op_sel_hi:[0,1]
    v_cvt_pk_bf16_f32 v129, v118, v119
    ds_write_b32 v79, v129 offset:25344
    v_cvt_pk_bf16_f32 v126, v138, v139
    ds_write_b32 v79, v126 offset:25872
    v_cvt_pk_bf16_f32 v127, v122, v123
    ds_write_b32 v79, v127 offset:26400
    v_cvt_pk_bf16_f32 v128, v94, -v95
    ds_write_b32 v79, v128 offset:7392
    v_pk_fma_f32 v[124:125], v[142:143], v[92:93], v[124:125] op_sel:[1,1,0] op_sel_hi:[1,0,1] neg_lo:[0,1,0]
    v_pk_fma_f32 v[136:137], v[118:119], v[92:93], v[136:137] op_sel:[1,1,0] op_sel_hi:[1,0,1] neg_lo:[0,1,0]
    v_pk_fma_f32 v[120:121], v[138:139], v[92:93], v[120:121] op_sel:[1,1,0] op_sel_hi:[1,0,1] neg_lo:[0,1,0]
    v_pk_fma_f32 v[98:99], v[94:95], v[88:89], v[98:99] op_sel:[1,1,0] op_sel_hi:[1,0,1] neg_lo:[0,1,0]
    v_pk_mul_f32 v[140:141], v[122:123], v[92:93] op_sel:[0,0] op_sel_hi:[0,1]
    v_pk_mul_f32 v[142:143], v[124:125], v[92:93] op_sel:[0,0] op_sel_hi:[0,1]
    v_pk_mul_f32 v[94:95], v[98:99], v[88:89] op_sel:[0,0] op_sel_hi:[0,1]
    v_cvt_pk_bf16_f32 v129, v124, v125
    ds_write_b32 v79, v129 offset:26928
    v_cvt_pk_bf16_f32 v126, v136, v137
    ds_write_b32 v79, v126 offset:27456
    v_cvt_pk_bf16_f32 v127, v120, v121
    ds_write_b32 v79, v127 offset:27984
    v_cvt_pk_bf16_f32 v128, v98, -v99
    ds_write_b32 v79, v128 offset:7920
    v_pk_fma_f32 v[140:141], v[122:123], v[92:93], v[140:141] op_sel:[1,1,0] op_sel_hi:[1,0,1] neg_lo:[0,1,0]
    v_pk_fma_f32 v[142:143], v[124:125], v[92:93], v[142:143] op_sel:[1,1,0] op_sel_hi:[1,0,1] neg_lo:[0,1,0]
    v_pk_fma_f32 v[94:95], v[98:99], v[88:89], v[94:95] op_sel:[1,1,0] op_sel_hi:[1,0,1] neg_lo:[0,1,0]
    v_pk_mul_f32 v[98:99], v[94:95], v[88:89] op_sel:[0,0] op_sel_hi:[0,1]
    v_cvt_pk_bf16_f32 v129, v140, v141
    ds_write_b32 v79, v129 offset:28512
    v_cvt_pk_bf16_f32 v126, v142, v143
    ds_write_b32 v79, v126 offset:29040
    v_cvt_pk_bf16_f32 v127, v94, -v95
    ds_write_b32 v79, v127 offset:10560
    v_pk_fma_f32 v[98:99], v[94:95], v[88:89], v[98:99] op_sel:[1,1,0] op_sel_hi:[1,0,1] neg_lo:[0,1,0]
    v_pk_mul_f32 v[94:95], v[98:99], v[88:89] op_sel:[0,0] op_sel_hi:[0,1]
    v_cvt_pk_bf16_f32 v128, v98, -v99
    ds_write_b32 v79, v128 offset:11088
    v_pk_fma_f32 v[94:95], v[98:99], v[88:89], v[94:95] op_sel:[1,1,0] op_sel_hi:[1,0,1] neg_lo:[0,1,0]
    v_cvt_pk_bf16_f32 v129, v94, -v95
    ds_write_b32 v79, v129 offset:11616
    s_waitcnt lgkmcnt(0)
    s_waitcnt vmcnt(0)
    s_barrier
    s_cmp_lg_u32 s3, 0
    s_cbranch_scc1 Lb1a
    v_cmp_ne_u32 vcc, 0, v75
    s_cmp_eq_u32 vcc_lo, 0xffff
    s_cbranch_scc1 Lb1a
    v_lshlrev_b32 v5, 2, v0
    v_add_u32 v5, 128, v5
    s_mov_b64 exec, 65535
    s_mov_b32 s86, 0
Lb0:
    buffer_load_dword v6, v5, s[88:91], 0 offen sc1
    s_add_u32 s86, s86, 1
    s_waitcnt vmcnt(0)
    v_cmp_ne_u32 vcc, 1, v6
    s_cmp_gt_u32 s86, 200000
    s_cbranch_scc1 Lb0x
    s_cbranch_vccnz Lb0
Lb0x:
    s_mov_b64 exec, -1
Lb1a:
    s_lshl_b32 s5, s30, 8
    s_add_u32 s5, s5, 491520
    v_mov_b32 v5, 1
    buffer_atomic_add v5, v4, s[40:43], s5 offen sc1
    s_bfe_u32 s4, s2, 0x20003
    s_mul_i32 s4, s4, 458752
    s_lshr_b32 s5, s65, 2
    s_lshl_b32 s5, s5, 7
    s_add_u32 s4, s4, s5
    s_movk_i32 s5, 3584
    v_and_b32 v5, 127, v0
    v_mul_u32_u24 v5, s5, v5
    s_cmp_lt_u32 s3, 2
    s_cselect_b32 s5, 1073741824, 0
    v_or_b32 v5, s5, v5
    buffer_load_dword v250, v5, s[56:59], s4 offen
    s_and_b32 s4, s2, 3
    s_lshl_b32 s4, s4, 2
    s_bfe_u32 s5, s2, 0x20003
    s_add_u32 s82, s4, s5
    s_bfe_u32 s4, s2, 0x10002
    s_lshl_b32 s4, s4, 3
    s_lshr_b32 s85, s2, 5
    s_add_u32 s83, s4, s85
    s_and_b32 s4, s2, 7
    s_lshl_b32 s4, s4, 2
    s_add_u32 s84, s4, s5
    s_lshr_b32 s4, s3, 1
    s_lshl_b32 s5, s85, 1
    s_add_u32 s5, s5, s4
    s_mul_i32 s6, s3, 28672
    s_add_u32 s6, s6, 12582912
    s_mul_i32 s22, s5, 114688
    s_add_u32 s22, s22, s6
    s_xor_b32 s7, s5, 1
    s_mul_i32 s23, s7, 114688
    s_add_u32 s23, s23, s6
    s_lshl_b32 s5, s5, 7
    v_and_b32 v5, 31, v0
    v_lshl_add_u32 v45, v5, 2, s5
    v_and_b32 v5, 3, v0
    v_bfe_u32 v6, v0, 2, 2
    v_lshlrev_b32 v6, 11, v6
    s_movk_i32 s5, 12288
    v_mad_u32_u24 v44, v5, s5, v6
    v_lshlrev_b32 v46, 3, v0
    v_add_u32 v46, 98816, v46
    v_lshrrev_b32 v5, 3, v0
    v_and_b32 v6, 7, v0
    v_lshlrev_b32 v47, 5, v5
    v_lshlrev_b32 v7, 4, v6
    v_lshl_add_u32 v7, v5, 9, v7
    v_add_u32 v48, s64, v7
    v_lshlrev_b32 v51, 3, v6
    v_bfe_u32 v5, v0, 4, 1
    v_lshl_add_u32 v7, v5, 2, v51
    v_bfe_u32 v5, v0, 5, 1
    v_lshl_add_u32 v7, v5, 6, v7
    s_lshl_b32 s5, s3, 7
    s_add_u32 s5, s5, 13824
    v_add_u32 v50, s5, v7
    v_and_b32 v7, 3, v0
    v_lshlrev_b32 v7, 2, v7
    v_bfe_u32 v5, v0, 2, 1
    v_lshl_add_u32 v7, v5, 6, v7
    v_bfe_u32 v5, v0, 3, 1
    v_lshl_add_u32 v7, v5, 4, v7
    v_mov_b32 v5, 1073741824
    v_cmp_gt_u32 vcc, 16, v0
    s_nop 1
    v_cndmask_b32 v7, v5, v7, vcc
    v_or_b32 v49, s64, v7
    s_mul_i32 s18, s65, 9363
    s_lshr_b32 s18, s18, 16
    s_lshl_b32 s18, s18, 8
    s_add_u32 s18, s18, 425984
    s_mov_b32 s15, 0xbf317218
    s_cmp_eq_u32 s66, 0
    s_cselect_b32 s15, 0xbfb8aa3b, s15
    v_and_b32 v5, 15, v0
    v_bfe_u32 v6, v0, 4, 2
    s_and_b32 s5, s3, 1
    s_lshl_b32 s5, s5, 8
    s_mul_i32 s6, s4, 4608
    s_add_u32 s6, s6, 98592
    s_sub_u32 s6, s6, s5
    v_lshl_add_u32 v7, v6, 4, s6
    v_lshl_add_u32 v220, v5, 5, v7
    s_mul_i32 s6, s4, 8320
    s_add_u32 s6, s6, 110880
    s_sub_u32 s6, s6, s5
    v_lshl_add_u32 v7, v6, 4, s6
    v_and_b32 v216, 1, v5
    s_movk_i32 s6, 4160
    v_mad_u32_u24 v7, v216, s6, v7
    v_add_u32 v216, 1, v5
    v_lshrrev_b32 v216, 1, v216
    v_lshlrev_b32 v216, 2, v216
    v_sub_u32 v216, v7, v216
    v_subrev_u32 v217, 1024, v216
    v_subrev_u32 v218, 2048, v216
    v_subrev_u32 v219, 3072, v216
    v_lshrrev_b32 v7, 1, v5
    v_add_u32 v7, v7, v6
    v_and_b32 v7, 3, v7
    v_lshlrev_b32 v7, 4, v7
    v_lshl_add_u32 v7, v5, 6, v7
    s_lshl_b32 s5, s3, 13
    s_add_u32 s5, s5, 124160
    v_add_u32 v221, s5, v7
    v_lshrrev_b32 v7, 3, v0
    v_add_u32 v7, v7, v0
    v_and_b32 v7, 3, v7
    v_and_b32 v6, 0xfc, v0
    v_or_b32 v7, v7, v6
    v_lshlrev_b32 v7, 4, v7
    v_add_u32 v222, 124160, v7
    v_lshlrev_b32 v6, 7, v0
    v_mov_b32 v5, 1073741824
    v_cmp_gt_u32 vcc, 8, v0
    s_nop 1
    v_cndmask_b32 v6, v5, v6, vcc
    v_mov_b32 v5, 0
    s_lshl_b32 s5, s2, 10
    s_add_u32 s5, s5, 786432
    buffer_store_dword v5, v6, s[40:43], s5 offen sc1
    ds_read_b128 v[80:83], v185 offset:0
    ds_read_b128 v[84:87], v184 offset:0
    ds_read_b128 v[88:91], v184 offset:8448
    ds_read_b128 v[92:95], v185 offset:64
    ds_read_b128 v[96:99], v184 offset:64
    ds_read_b128 v[100:103], v184 offset:8512
    ds_read_b128 v[104:107], v185 offset:128
    ds_read_b128 v[108:111], v184 offset:128
    ds_read_b128 v[112:115], v184 offset:8576
    ds_read_b128 v[116:119], v185 offset:192
    ds_read_b128 v[120:123], v184 offset:192
    ds_read_b128 v[124:127], v184 offset:8640
    ds_read_b128 v[128:131], v185 offset:256
    ds_read_b128 v[132:135], v184 offset:256
    ds_read_b128 v[136:139], v184 offset:8704
    ds_read_b128 v[140:143], v185 offset:320
    ds_read_b128 v[144:147], v184 offset:320
    ds_read_b128 v[148:151], v184 offset:8768
    ds_read_b128 v[152:155], v185 offset:384
    ds_read_b128 v[156:159], v184 offset:384
    ds_read_b128 v[160:163], v184 offset:8832
    ds_read_b128 v[164:167], v185 offset:448
    ds_read_b128 v[168:171], v184 offset:448
    ds_read_b128 v[172:175], v184 offset:8896
    s_waitcnt lgkmcnt(15)
    v_mfma_f32_16x16x32_bf16 v[8:11], v[84:87], v[80:83], 0
    v_mfma_f32_16x16x32_bf16 v[12:15], v[88:91], v[80:83], 0
    v_mfma_f32_16x16x32_bf16 v[8:11], v[96:99], v[92:95], v[8:11]
    v_mfma_f32_16x16x32_bf16 v[12:15], v[100:103], v[92:95], v[12:15]
    v_mfma_f32_16x16x32_bf16 v[8:11], v[108:111], v[104:107], v[8:11]
    v_mfma_f32_16x16x32_bf16 v[12:15], v[112:115], v[104:107], v[12:15]
    s_waitcnt lgkmcnt(12)
    v_mfma_f32_16x16x32_bf16 v[8:11], v[120:123], v[116:119], v[8:11]
    v_mfma_f32_16x16x32_bf16 v[12:15], v[124:127], v[116:119], v[12:15]
    s_waitcnt lgkmcnt(9)
    v_mfma_f32_16x16x32_bf16 v[8:11], v[132:135], v[128:131], v[8:11]
    v_mfma_f32_16x16x32_bf16 v[12:15], v[136:139], v[128:131], v[12:15]
    s_waitcnt lgkmcnt(6)
    v_mfma_f32_16x16x32_bf16 v[8:11], v[144:147], v[140:143], v[8:11]
    v_mfma_f32_16x16x32_bf16 v[12:15], v[148:151], v[140:143], v[12:15]
    s_waitcnt lgkmcnt(3)
    v_mfma_f32_16x16x32_bf16 v[8:11], v[156:159], v[152:155], v[8:11]
    v_mfma_f32_16x16x32_bf16 v[12:15], v[160:163], v[152:155], v[12:15]
    s_waitcnt lgkmcnt(0)
    v_mfma_f32_16x16x32_bf16 v[8:11], v[168:171], v[164:167], v[8:11]
    v_mfma_f32_16x16x32_bf16 v[12:15], v[172:175], v[164:167], v[12:15]
    s_nop 6
    v_cvt_pk_bf16_f32 v8, v8, v9
    v_cvt_pk_bf16_f32 v9, v10, v11
    v_cvt_pk_bf16_f32 v12, v12, v13
    v_cvt_pk_bf16_f32 v13, v14, v15
    ds_write_b16 v186, v8
    ds_write_b16_d16_hi v189, v8
    ds_write_b16 v190, v9
    ds_write_b16_d16_hi v191, v9
    ds_write_b16 v188, v12 offset:0
    ds_write_b16_d16_hi v188, v12 offset:512
    ds_write_b16 v188, v13 offset:1024
    ds_write_b16_d16_hi v188, v13 offset:1536
    s_waitcnt lgkmcnt(0)
    s_barrier
    ds_read_u16 v40, v207
    ds_read_u16 v80, v192 offset:0
    ds_read_u16 v81, v193 offset:0
    ds_read_u16 v82, v194 offset:0
    buffer_load_dword v56, v78, s[56:59], s29 offen offset:0
    ds_read_u16 v83, v195 offset:512
    ds_read_u16 v84, v196 offset:512
    ds_read_u16 v85, v197 offset:512
    buffer_load_dword v57, v78, s[56:59], s29 offen offset:3584
    s_add_u32 s29, s29, 7168
    ds_read_u16 v86, v198 offset:1024
    ds_read_u16 v87, v199 offset:1024
    ds_read_u16 v88, v200 offset:1024
    buffer_load_dword v58, v78, s[56:59], s29 offen offset:0
    ds_read_u16 v89, v198 offset:1536
    ds_read_u16 v90, v199 offset:1536
    ds_read_u16 v91, v200 offset:1536
    buffer_load_dword v59, v78, s[56:59], s29 offen offset:3584
    s_add_u32 s29, s29, 7168
    ds_read_u16 v92, v201 offset:2048
    ds_read_u16 v93, v202 offset:2048
    ds_read_u16 v94, v203 offset:2048
    buffer_load_dword v60, v78, s[56:59], s29 offen offset:0
    ds_read_u16 v95, v201 offset:2560
    ds_read_u16 v96, v202 offset:2560
    ds_read_u16 v97, v203 offset:2560
    buffer_load_dword v61, v78, s[56:59], s29 offen offset:3584
    s_add_u32 s29, s29, 7168
    ds_read_u16 v98, v201 offset:3072
    ds_read_u16 v99, v202 offset:3072
    ds_read_u16 v100, v203 offset:3072
    buffer_load_dword v62, v78, s[56:59], s29 offen offset:0
    ds_read_u16 v101, v201 offset:3584
    ds_read_u16 v102, v202 offset:3584
    ds_read_u16 v103, v203 offset:3584
    buffer_load_dword v63, v78, s[56:59], s29 offen offset:3584
    s_add_u32 s29, s29, 896000
    v_and_b32 v5, 15, v0
    v_cmp_eq_u32 vcc, 0, v5
    v_mov_b32 v7, 0
    s_waitcnt lgkmcnt(15)
    v_cndmask_b32 v40, v7, v40, vcc
    ds_write_b32 v206, v40
    v_lshl_or_b32 v80, v81, 16, v80
    v_lshl_or_b32 v81, v82, 16, v81
    ds_write_b32 v204, v80 offset:3584
    ds_write_b32 v204, v81 offset:7744
    buffer_load_dword v64, v78, s[56:59], s29 offen offset:0
    v_lshl_or_b32 v83, v84, 16, v83
    v_lshl_or_b32 v84, v85, 16, v84
    ds_write_b32 v204, v83 offset:3072
    ds_write_b32 v204, v84 offset:7232
    buffer_load_dword v65, v78, s[56:59], s29 offen offset:3584
    s_add_u32 s29, s29, 7168
    v_lshl_or_b32 v86, v87, 16, v86
    v_lshl_or_b32 v87, v88, 16, v87
    ds_write_b32 v204, v86 offset:2560
    ds_write_b32 v204, v87 offset:6720
    buffer_load_dword v66, v78, s[56:59], s29 offen offset:0
    s_waitcnt lgkmcnt(15)
    v_lshl_or_b32 v89, v90, 16, v89
    v_lshl_or_b32 v90, v91, 16, v90
    ds_write_b32 v204, v89 offset:2048
    ds_write_b32 v204, v90 offset:6208
    buffer_load_dword v67, v78, s[56:59], s29 offen offset:3584
    s_add_u32 s29, s29, 7168
    v_lshl_or_b32 v92, v93, 16, v92
    v_lshl_or_b32 v93, v94, 16, v93
    ds_write_b32 v204, v92 offset:1536
    ds_write_b32 v204, v93 offset:5696
    buffer_load_dword v68, v78, s[56:59], s29 offen offset:0
    s_waitcnt lgkmcnt(15)
    v_lshl_or_b32 v95, v96, 16, v95
    v_lshl_or_b32 v96, v97, 16, v96
    ds_write_b32 v204, v95 offset:1024
    ds_write_b32 v204, v96 offset:5184
    buffer_load_dword v69, v78, s[56:59], s29 offen offset:3584
    s_add_u32 s29, s29, 7168
    s_waitcnt lgkmcnt(15)
    v_lshl_or_b32 v98, v99, 16, v98
    v_lshl_or_b32 v99, v100, 16, v99
    ds_write_b32 v204, v98 offset:512
    ds_write_b32 v204, v99 offset:4672
    buffer_load_dword v70, v78, s[56:59], s29 offen offset:0
    s_waitcnt lgkmcnt(15)
    v_lshl_or_b32 v101, v102, 16, v101
    v_lshl_or_b32 v102, v103, 16, v102
    ds_write_b32 v204, v101 offset:0
    ds_write_b32 v204, v102 offset:4160
    buffer_load_dword v71, v78, s[56:59], s29 offen offset:3584
    s_cmp_lg_u32 s3, 0
    s_cbranch_scc1 Lb1w
    v_lshlrev_b32 v5, 8, v0
    s_and_b32 s5, s2, 7
    s_lshl_b32 s5, s5, 12
    s_add_u32 s5, s5, 491520
    s_mov_b64 exec, 65535
    s_mov_b32 s86, 0
Lb1:
    buffer_load_dword v6, v5, s[40:43], s5 offen sc1
    s_add_u32 s86, s86, 1
    s_waitcnt vmcnt(0)
    v_cmp_ne_u32 vcc, 16, v6
    s_cmp_gt_u32 s86, 200000
    s_cbranch_scc1 Lb1x
    s_cbranch_vccnz Lb1
Lb1x:
    s_mov_b64 exec, -1
Lb1w:
    s_waitcnt lgkmcnt(0)
    s_barrier
    s_mov_b32 s4, 137216
    buffer_load_dwordx4 v[8:11], v1, s[40:43], s4 offen sc1
    s_add_u32 s4, s4, 12288
    buffer_load_dwordx4 v[12:15], v1, s[40:43], s4 offen sc1
    s_add_u32 s4, s4, 12288
    buffer_load_dwordx4 v[16:19], v1, s[40:43], s4 offen sc1
    s_add_u32 s4, s4, 12288
    buffer_load_dwordx4 v[20:23], v1, s[40:43], s4 offen sc1
    s_add_u32 s4, s4, 12288
    s_lshl_b32 s4, s2, 3
    s_add_u32 s4, s4, 131072
    buffer_load_dwordx2 v[24:25], v44, s[40:43], s4 offen sc1
    s_mul_i32 s4, s2, 8448
    s_add_u32 s4, s4, 1048576
    s_mov_b32 s5, 65536
    s_mov_b32 s6, 73728
    buffer_load_dwordx4 v[26:29], v1, s[40:43], s4 offen sc1
    buffer_load_dwordx4 v[88:91], v1, s[40:43], s5 offen sc1
    buffer_load_dwordx4 v[96:99], v1, s[40:43], s6 offen sc1
    s_add_u32 s4, s4, 4096
    s_add_u32 s5, s5, 4096
    s_add_u32 s6, s6, 4096
    buffer_load_dwordx4 v[30:33], v1, s[40:43], s4 offen sc1
    buffer_load_dwordx4 v[92:95], v1, s[40:43], s5 offen sc1
    buffer_load_dwordx4 v[100:103], v1, s[40:43], s6 offen sc1
    s_mov_b32 s4, 141312
    buffer_load_dword v34, v45, s[40:43], s4 offen sc1
    s_add_u32 s4, s4, 12288
    buffer_load_dword v35, v45, s[40:43], s4 offen sc1
    s_add_u32 s4, s4, 12288
    buffer_load_dword v36, v45, s[40:43], s4 offen sc1
    s_add_u32 s4, s4, 12288
    buffer_load_dword v37, v45, s[40:43], s4 offen sc1
    s_cmp_ge_u32 s3, 2
    s_cselect_b32 s4, 1.0, 0
    s_waitcnt vmcnt(11)
    v_pk_add_f32 v[8:9], v[8:9], v[12:13]
    v_pk_add_f32 v[16:17], v[16:17], v[20:21]
    v_pk_add_f32 v[10:11], v[10:11], v[14:15]
    v_pk_add_f32 v[18:19], v[18:19], v[22:23]
    v_pk_add_f32 v[8:9], v[8:9], v[16:17]
    v_pk_add_f32 v[10:11], v[10:11], v[18:19]
    v_cvt_pk_bf16_f32 v12, v8, v9
    v_cvt_pk_bf16_f32 v13, v10, v11
    v_lshlrev_b32 v8, 16, v12
    v_and_b32 v9, s87, v12
    v_lshlrev_b32 v10, 16, v13
    v_and_b32 v11, s87, v13
    v_add_f32 v8, s4, v8
    v_add_f32 v9, s4, v9
    v_add_f32 v10, s4, v10
    v_add_f32 v11, s4, v11
    v_cvt_pk_bf16_f32 v12, v8, v9
    v_cvt_pk_bf16_f32 v13, v10, v11
    v_lshlrev_b32 v8, 16, v12
    v_and_b32 v9, s87, v12
    v_lshlrev_b32 v10, 16, v13
    v_and_b32 v11, s87, v13
    ds_write_b128 v1, v[8:11] offset:9728
    s_waitcnt vmcnt(10)
    v_add_f32_dpp v24, v24, v24 quad_perm:[1,0,3,2] row_mask:0xf bank_mask:0xf
    v_add_f32_dpp v25, v25, v25 quad_perm:[1,0,3,2] row_mask:0xf bank_mask:0xf
    s_nop 0
    v_add_f32_dpp v24, v24, v24 quad_perm:[2,3,0,1] row_mask:0xf bank_mask:0xf
    v_add_f32_dpp v25, v25, v25 quad_perm:[2,3,0,1] row_mask:0xf bank_mask:0xf
    v_cvt_pk_bf16_f32 v5, v24, v25
    v_lshlrev_b32 v12, 16, v5
    v_and_b32 v13, s87, v5
    v_add_f32 v14, 1.0, v12
    v_add_f32 v15, 1.0, v13
    v_mul_f32 v16, s16, v12
    v_cvt_pk_bf16_f32 v5, v14, v15
    v_mul_f32 v17, s17, v13
    v_lshlrev_b32 v14, 16, v5
    v_and_b32 v15, s87, v5
    v_readlane_b32 s75, v12, 0
    v_readlane_b32 s77, v13, 0
    v_readlane_b32 s79, v12, 8
    v_readlane_b32 s81, v13, 8
    v_readlane_b32 s78, v16, 8
    v_readlane_b32 s80, v17, 8
    v_readlane_b32 s74, v14, 4
    v_readlane_b32 s76, v15, 4
    s_waitcnt vmcnt(7)
    v_lshlrev_b32 v72, 16, v26
    v_and_b32 v80, s87, v26
    v_lshlrev_b32 v73, 16, v27
    v_and_b32 v81, s87, v27
    v_lshlrev_b32 v74, 16, v28
    v_and_b32 v82, s87, v28
    v_lshlrev_b32 v75, 16, v29
    v_and_b32 v83, s87, v29
    v_pk_fma_f32 v[104:105], v[72:73], v[88:89], v[96:97]
    v_pk_fma_f32 v[106:107], v[74:75], v[90:91], v[98:99]
    v_pk_fma_f32 v[108:109], v[80:81], v[88:89], v[96:97]
    v_pk_fma_f32 v[110:111], v[82:83], v[90:91], v[98:99]
    v_pk_fma_f32 v[104:105], v[104:105], s[74:75], s[74:75] op_sel:[0,0,1] op_sel_hi:[1,0,1]
    v_pk_fma_f32 v[106:107], v[106:107], s[74:75], s[74:75] op_sel:[0,0,1] op_sel_hi:[1,0,1]
    v_pk_fma_f32 v[108:109], v[108:109], s[76:77], s[76:77] op_sel:[0,0,1] op_sel_hi:[1,0,1]
    v_pk_fma_f32 v[110:111], v[110:111], s[76:77], s[76:77] op_sel:[0,0,1] op_sel_hi:[1,0,1]
    v_cvt_pk_bf16_f32 v112, v104, v105
    v_cvt_pk_bf16_f32 v113, v106, v107
    v_cvt_pk_bf16_f32 v114, v108, v109
    v_cvt_pk_bf16_f32 v115, v110, v111
    ds_write_b64 v46, v[112:113] offset:0
    ds_write_b64 v46, v[114:115] offset:4608
    v_pk_fma_f32 v[72:73], v[104:105], s[78:79], v[72:73] op_sel:[0,0,0] op_sel_hi:[1,0,1]
    v_pk_fma_f32 v[74:75], v[106:107], s[78:79], v[74:75] op_sel:[0,0,0] op_sel_hi:[1,0,1]
    v_pk_fma_f32 v[80:81], v[108:109], s[80:81], v[80:81] op_sel:[0,0,0] op_sel_hi:[1,0,1]
    v_pk_fma_f32 v[82:83], v[110:111], s[80:81], v[82:83] op_sel:[0,0,0] op_sel_hi:[1,0,1]
    s_waitcnt vmcnt(4)
    v_lshlrev_b32 v76, 16, v30
    v_and_b32 v84, s87, v30
    v_lshlrev_b32 v77, 16, v31
    v_and_b32 v85, s87, v31
    v_lshlrev_b32 v78, 16, v32
    v_and_b32 v86, s87, v32
    v_lshlrev_b32 v79, 16, v33
    v_and_b32 v87, s87, v33
    v_pk_fma_f32 v[104:105], v[76:77], v[92:93], v[100:101]
    v_pk_fma_f32 v[106:107], v[78:79], v[94:95], v[102:103]
    v_pk_fma_f32 v[108:109], v[84:85], v[92:93], v[100:101]
    v_pk_fma_f32 v[110:111], v[86:87], v[94:95], v[102:103]
    v_pk_fma_f32 v[104:105], v[104:105], s[74:75], s[74:75] op_sel:[0,0,1] op_sel_hi:[1,0,1]
    v_pk_fma_f32 v[106:107], v[106:107], s[74:75], s[74:75] op_sel:[0,0,1] op_sel_hi:[1,0,1]
    v_pk_fma_f32 v[108:109], v[108:109], s[76:77], s[76:77] op_sel:[0,0,1] op_sel_hi:[1,0,1]
    v_pk_fma_f32 v[110:111], v[110:111], s[76:77], s[76:77] op_sel:[0,0,1] op_sel_hi:[1,0,1]
    v_cvt_pk_bf16_f32 v112, v104, v105
    v_cvt_pk_bf16_f32 v113, v106, v107
    v_cvt_pk_bf16_f32 v114, v108, v109
    v_cvt_pk_bf16_f32 v115, v110, v111
    ds_write_b64 v46, v[112:113] offset:2048
    ds_write_b64 v46, v[114:115] offset:6656
    v_pk_fma_f32 v[76:77], v[104:105], s[78:79], v[76:77] op_sel:[0,0,0] op_sel_hi:[1,0,1]
    v_pk_fma_f32 v[78:79], v[106:107], s[78:79], v[78:79] op_sel:[0,0,0] op_sel_hi:[1,0,1]
    v_pk_fma_f32 v[84:85], v[108:109], s[80:81], v[84:85] op_sel:[0,0,0] op_sel_hi:[1,0,1]
    v_pk_fma_f32 v[86:87], v[110:111], s[80:81], v[86:87] op_sel:[0,0,0] op_sel_hi:[1,0,1]
    s_waitcnt vmcnt(0)
    v_add_f32 v34, v34, v35
    v_add_f32 v36, v36, v37
    v_and_b32 v5, 31, v0
    s_lshl_b32 s4, s3, 7
    s_add_u32 s4, s4, 160768
    v_add_f32 v34, v34, v36
    v_lshl_add_u32 v5, v5, 2, s4
    v_cvt_pk_bf16_f32 v34, v34, v34
    v_lshlrev_b32 v34, 16, v34
    ds_write_b32 v5, v34
    s_waitcnt lgkmcnt(0)
    s_barrier
    ds_read_b128 v[120:123], v47 offset:9728
    ds_read_b128 v[128:131], v47 offset:11776
    ds_read_b128 v[124:127], v47 offset:9744
    ds_read_b128 v[132:135], v47 offset:11792
    ds_read_b128 v[136:139], v47 offset:10752
    ds_read_b128 v[144:147], v47 offset:12800
    ds_read_b128 v[140:143], v47 offset:10768
    ds_read_b128 v[148:151], v47 offset:12816
    v_lshlrev_b32 v88, 16, v56
    v_and_b32 v89, s87, v56
    v_lshlrev_b32 v90, 16, v57
    v_and_b32 v91, s87, v57
    v_lshlrev_b32 v92, 16, v58
    v_and_b32 v93, s87, v58
    v_lshlrev_b32 v94, 16, v59
    v_and_b32 v95, s87, v59
    v_lshlrev_b32 v96, 16, v60
    v_and_b32 v97, s87, v60
    v_lshlrev_b32 v98, 16, v61
    v_and_b32 v99, s87, v61
    v_lshlrev_b32 v100, 16, v62
    v_and_b32 v101, s87, v62
    v_lshlrev_b32 v102, 16, v63
    v_and_b32 v103, s87, v63
    v_lshlrev_b32 v104, 16, v64
    v_and_b32 v105, s87, v64
    v_lshlrev_b32 v106, 16, v65
    v_and_b32 v107, s87, v65
    v_lshlrev_b32 v108, 16, v66
    v_and_b32 v109, s87, v66
    v_lshlrev_b32 v110, 16, v67
    v_and_b32 v111, s87, v67
    v_lshlrev_b32 v112, 16, v68
    v_and_b32 v113, s87, v68
    v_lshlrev_b32 v114, 16, v69
    v_and_b32 v115, s87, v69
    v_lshlrev_b32 v116, 16, v70
    v_and_b32 v117, s87, v70
    v_lshlrev_b32 v118, 16, v71
    v_and_b32 v119, s87, v71
    s_waitcnt lgkmcnt(6)
    v_pk_mul_f32 v[12:13], v[88:89], v[120:121] op_sel:[0,0] op_sel_hi:[1,0]
    v_pk_mul_f32 v[88:89], v[88:89], v[128:129] op_sel:[0,0] op_sel_hi:[1,0]
    v_pk_mul_f32 v[14:15], v[90:91], v[120:121] op_sel:[0,1] op_sel_hi:[1,1]
    v_pk_mul_f32 v[90:91], v[90:91], v[128:129] op_sel:[0,1] op_sel_hi:[1,1]
    v_pk_fma_f32 v[12:13], v[92:93], v[122:123], v[12:13] op_sel:[0,0,0] op_sel_hi:[1,0,1]
    v_pk_mul_f32 v[92:93], v[92:93], v[130:131] op_sel:[0,0] op_sel_hi:[1,0]
    v_pk_add_f32 v[8:9], v[88:89], v[92:93]
    v_pk_fma_f32 v[14:15], v[94:95], v[122:123], v[14:15] op_sel:[0,1,0] op_sel_hi:[1,1,1]
    v_pk_mul_f32 v[94:95], v[94:95], v[130:131] op_sel:[0,1] op_sel_hi:[1,1]
    v_pk_add_f32 v[10:11], v[90:91], v[94:95]
    s_waitcnt lgkmcnt(4)
    v_pk_fma_f32 v[12:13], v[96:97], v[124:125], v[12:13] op_sel:[0,0,0] op_sel_hi:[1,0,1]
    v_pk_mul_f32 v[96:97], v[96:97], v[132:133] op_sel:[0,0] op_sel_hi:[1,0]
    v_pk_add_f32 v[8:9], v[8:9], v[96:97]
    v_pk_fma_f32 v[14:15], v[98:99], v[124:125], v[14:15] op_sel:[0,1,0] op_sel_hi:[1,1,1]
    v_pk_mul_f32 v[98:99], v[98:99], v[132:133] op_sel:[0,1] op_sel_hi:[1,1]
    v_pk_add_f32 v[10:11], v[10:11], v[98:99]
    v_pk_fma_f32 v[12:13], v[100:101], v[126:127], v[12:13] op_sel:[0,0,0] op_sel_hi:[1,0,1]
    v_pk_mul_f32 v[100:101], v[100:101], v[134:135] op_sel:[0,0] op_sel_hi:[1,0]
    v_pk_add_f32 v[8:9], v[8:9], v[100:101]
    v_pk_fma_f32 v[14:15], v[102:103], v[126:127], v[14:15] op_sel:[0,1,0] op_sel_hi:[1,1,1]
    v_pk_mul_f32 v[102:103], v[102:103], v[134:135] op_sel:[0,1] op_sel_hi:[1,1]
    v_pk_add_f32 v[10:11], v[10:11], v[102:103]
    s_waitcnt lgkmcnt(2)
    v_pk_fma_f32 v[12:13], v[104:105], v[136:137], v[12:13] op_sel:[0,0,0] op_sel_hi:[1,0,1]
    v_pk_mul_f32 v[104:105], v[104:105], v[144:145] op_sel:[0,0] op_sel_hi:[1,0]
    v_pk_add_f32 v[8:9], v[8:9], v[104:105]
    v_pk_fma_f32 v[14:15], v[106:107], v[136:137], v[14:15] op_sel:[0,1,0] op_sel_hi:[1,1,1]
    v_pk_mul_f32 v[106:107], v[106:107], v[144:145] op_sel:[0,1] op_sel_hi:[1,1]
    v_pk_add_f32 v[10:11], v[10:11], v[106:107]
    v_pk_fma_f32 v[12:13], v[108:109], v[138:139], v[12:13] op_sel:[0,0,0] op_sel_hi:[1,0,1]
    v_pk_mul_f32 v[108:109], v[108:109], v[146:147] op_sel:[0,0] op_sel_hi:[1,0]
    v_pk_add_f32 v[8:9], v[8:9], v[108:109]
    v_pk_fma_f32 v[14:15], v[110:111], v[138:139], v[14:15] op_sel:[0,1,0] op_sel_hi:[1,1,1]
    v_pk_mul_f32 v[110:111], v[110:111], v[146:147] op_sel:[0,1] op_sel_hi:[1,1]
    v_pk_add_f32 v[10:11], v[10:11], v[110:111]
    s_waitcnt lgkmcnt(0)
    v_pk_fma_f32 v[12:13], v[112:113], v[140:141], v[12:13] op_sel:[0,0,0] op_sel_hi:[1,0,1]
    v_pk_mul_f32 v[112:113], v[112:113], v[148:149] op_sel:[0,0] op_sel_hi:[1,0]
    v_pk_add_f32 v[8:9], v[8:9], v[112:113]
    v_pk_fma_f32 v[14:15], v[114:115], v[140:141], v[14:15] op_sel:[0,1,0] op_sel_hi:[1,1,1]
    v_pk_mul_f32 v[114:115], v[114:115], v[148:149] op_sel:[0,1] op_sel_hi:[1,1]
    v_pk_add_f32 v[10:11], v[10:11], v[114:115]
    v_pk_fma_f32 v[12:13], v[116:117], v[142:143], v[12:13] op_sel:[0,0,0] op_sel_hi:[1,0,1]
    v_pk_mul_f32 v[116:117], v[116:117], v[150:151] op_sel:[0,0] op_sel_hi:[1,0]
    v_pk_add_f32 v[8:9], v[8:9], v[116:117]
    v_pk_fma_f32 v[14:15], v[118:119], v[142:143], v[14:15] op_sel:[0,1,0] op_sel_hi:[1,1,1]
    v_pk_mul_f32 v[118:119], v[118:119], v[150:151] op_sel:[0,1] op_sel_hi:[1,1]
    v_pk_add_f32 v[10:11], v[10:11], v[118:119]
    v_pk_add_f32 v[8:9], v[8:9], v[10:11]
    v_pk_add_f32 v[12:13], v[12:13], v[14:15]
    s_nop 1
    v_permlane32_swap_b32 v8, v12
    v_permlane32_swap_b32 v9, v13
    v_pk_add_f32 v[8:9], v[8:9], v[12:13]
    s_nop 1
    v_permlane16_swap_b32 v8, v9
    v_add_f32 v8, v8, v9
    s_nop 1
    v_add_f32_dpp v8, v8, v8 row_ror:8 row_mask:0xf bank_mask:0xf
    ds_write_b32 v50, v8
    s_waitcnt lgkmcnt(0)
    s_barrier
    ds_read_b64 v[8:9], v51 offset:13824
    ds_read_b64 v[10:11], v51 offset:13888
    ds_read_b64 v[12:13], v51 offset:13952
    ds_read_b64 v[14:15], v51 offset:14016
    ds_read_b64 v[16:17], v51 offset:14080
    ds_read_b64 v[18:19], v51 offset:14144
    ds_read_b64 v[20:21], v51 offset:14208
    ds_read_b64 v[22:23], v51 offset:14272
    ds_read2_b32 v[152:153], v216 offset0:176 offset1:177
    ds_read2_b32 v[154:155], v216 offset0:178 offset1:179
    ds_read_b128 v[184:187], v220 offset:192
    ds_read2_b32 v[156:157], v216 offset0:48 offset1:49
    ds_read2_b32 v[158:159], v216 offset0:50 offset1:51
    ds_read_b128 v[188:191], v220 offset:704
    s_waitcnt lgkmcnt(6)
    v_pk_add_f32 v[8:9], v[8:9], v[12:13]
    v_pk_add_f32 v[16:17], v[16:17], v[20:21]
    v_pk_add_f32 v[10:11], v[10:11], v[14:15]
    v_pk_add_f32 v[18:19], v[18:19], v[22:23]
    v_pk_add_f32 v[8:9], v[8:9], v[16:17]
    v_pk_add_f32 v[10:11], v[10:11], v[18:19]
    v_mul_f32 v8, 0xbb000000, v8
    v_mul_f32 v9, 0xbb000000, v9
    v_and_b32 v5, 8, v0
    v_cmp_eq_u32 vcc, 0, v5
    s_lshl_b32 s4, s65, 15
    s_lshl_b32 s5, s66, 8
    s_add_u32 s4, s4, s5
    s_add_u32 s4, s4, 8388608
    s_add_u32 s5, s4, 16384
    v_cndmask_b32 v10, v11, v10, vcc
    v_mul_f32 v10, s15, v10
    s_lshl_b32 s6, s65, 7
    s_lshl_b32 s7, s66, 5
    s_add_u32 s6, s6, s7
    s_add_u32 s6, s6, 262144
    buffer_store_dword v10, v49, s[40:43], s6 offen sc1
    v_pk_add_f32 v[88:89], v[88:89], v[8:9]
    ds_read2_b32 v[160:161], v217 offset0:176 offset1:177
    v_pk_add_f32 v[90:91], v[90:91], v[8:9]
    ds_read2_b32 v[162:163], v217 offset0:178 offset1:179
    v_pk_add_f32 v[92:93], v[92:93], v[8:9]
    ds_read_b128 v[192:195], v220 offset:1216
    v_pk_add_f32 v[94:95], v[94:95], v[8:9]
    ds_read2_b32 v[164:165], v217 offset0:48 offset1:49
    v_pk_add_f32 v[96:97], v[96:97], v[8:9]
    ds_read2_b32 v[166:167], v217 offset0:50 offset1:51
    v_pk_add_f32 v[98:99], v[98:99], v[8:9]
    ds_read_b128 v[196:199], v220 offset:1728
    v_pk_add_f32 v[100:101], v[100:101], v[8:9]
    ds_read2_b32 v[168:169], v218 offset0:176 offset1:177
    v_pk_add_f32 v[102:103], v[102:103], v[8:9]
    ds_read2_b32 v[170:171], v218 offset0:178 offset1:179
    v_cvt_pk_bf16_f32 v12, v88, v90
    v_cvt_pk_bf16_f32 v13, v96, v98
    v_cvt_pk_bf16_f32 v14, v92, v94
    v_cvt_pk_bf16_f32 v15, v100, v102
    buffer_store_dwordx4 v[12:15], v48, s[40:43], s4 offen offset:0 sc1
    ds_read_b128 v[200:203], v220 offset:2240
    v_cvt_pk_bf16_f32 v16, v89, v91
    v_cvt_pk_bf16_f32 v17, v97, v99
    v_cvt_pk_bf16_f32 v18, v93, v95
    v_cvt_pk_bf16_f32 v19, v101, v103
    buffer_store_dwordx4 v[16:19], v48, s[40:43], s4 offen offset:128 sc1
    ds_read2_b32 v[172:173], v218 offset0:48 offset1:49
    v_pk_add_f32 v[104:105], v[104:105], v[8:9]
    ds_read2_b32 v[174:175], v218 offset0:50 offset1:51
    v_pk_add_f32 v[106:107], v[106:107], v[8:9]
    ds_read_b128 v[204:207], v220 offset:2752
    v_pk_add_f32 v[108:109], v[108:109], v[8:9]
    ds_read2_b32 v[176:177], v219 offset0:176 offset1:177
    v_pk_add_f32 v[110:111], v[110:111], v[8:9]
    ds_read2_b32 v[178:179], v219 offset0:178 offset1:179
    v_pk_add_f32 v[112:113], v[112:113], v[8:9]
    ds_read_b128 v[208:211], v220 offset:3264
    v_pk_add_f32 v[114:115], v[114:115], v[8:9]
    ds_read2_b32 v[180:181], v219 offset0:48 offset1:49
    v_pk_add_f32 v[116:117], v[116:117], v[8:9]
    ds_read2_b32 v[182:183], v219 offset0:50 offset1:51
    v_pk_add_f32 v[118:119], v[118:119], v[8:9]
    ds_read_b128 v[212:215], v220 offset:3776
    v_cvt_pk_bf16_f32 v20, v104, v106
    v_cvt_pk_bf16_f32 v21, v112, v114
    v_cvt_pk_bf16_f32 v22, v108, v110
    v_cvt_pk_bf16_f32 v23, v116, v118
    buffer_store_dwordx4 v[20:23], v48, s[40:43], s5 offen offset:0 sc1
    v_cvt_pk_bf16_f32 v24, v105, v107
    v_cvt_pk_bf16_f32 v25, v113, v115
    v_cvt_pk_bf16_f32 v26, v109, v111
    v_cvt_pk_bf16_f32 v27, v117, v119
    buffer_store_dwordx4 v[24:27], v48, s[40:43], s5 offen offset:128 sc1
    s_waitcnt lgkmcnt(15)
    v_mfma_f32_16x16x32_bf16 v[224:227], v[152:155], v[184:187], 0
    v_mfma_f32_16x16x32_bf16 v[228:231], v[156:159], v[184:187], 0
    v_mfma_f32_16x16x32_bf16 v[228:231], v[152:155], v[188:191], v[228:231]
    v_mfma_f32_16x16x32_bf16 v[232:235], v[160:163], v[184:187], 0
    v_mfma_f32_16x16x32_bf16 v[232:235], v[156:159], v[188:191], v[232:235]
    buffer_load_dwordx4 a[0:3], v2, s[40:43], s22 offen offset:0 sc1
    v_mfma_f32_16x16x32_bf16 v[232:235], v[152:155], v[192:195], v[232:235]
    s_waitcnt lgkmcnt(12)
    v_mfma_f32_16x16x32_bf16 v[236:239], v[164:167], v[184:187], 0
    ds_read2_b32 v[88:89], v216 offset0:160 offset1:161
    v_mfma_f32_16x16x32_bf16 v[236:239], v[160:163], v[188:191], v[236:239]
    ds_read2_b32 v[90:91], v216 offset0:162 offset1:163
    v_mfma_f32_16x16x32_bf16 v[236:239], v[156:159], v[192:195], v[236:239]
    ds_read_b128 v[120:123], v220 offset:128
    buffer_load_dwordx4 a[4:7], v2, s[40:43], s23 offen offset:0 sc1
    v_mfma_f32_16x16x32_bf16 v[236:239], v[152:155], v[196:199], v[236:239]
    ds_read2_b32 v[92:93], v216 offset0:32 offset1:33
    s_waitcnt lgkmcnt(13)
    v_mfma_f32_16x16x32_bf16 v[240:243], v[168:171], v[184:187], 0
    ds_read2_b32 v[94:95], v216 offset0:34 offset1:35
    v_mfma_f32_16x16x32_bf16 v[240:243], v[164:167], v[188:191], v[240:243]
    ds_read_b128 v[124:127], v220 offset:640
    v_mfma_f32_16x16x32_bf16 v[240:243], v[160:163], v[192:195], v[240:243]
    ds_read2_b32 v[96:97], v217 offset0:160 offset1:161
    v_mfma_f32_16x16x32_bf16 v[240:243], v[156:159], v[196:199], v[240:243]
    ds_read2_b32 v[98:99], v217 offset0:162 offset1:163
    buffer_load_dwordx4 a[8:11], v2, s[40:43], s22 offen offset:1024 sc1
    v_mfma_f32_16x16x32_bf16 v[240:243], v[152:155], v[200:203], v[240:243]
    ds_read_b128 v[128:131], v220 offset:1152
    s_waitcnt lgkmcnt(15)
    v_mfma_f32_16x16x32_bf16 v[244:247], v[172:175], v[184:187], 0
    ds_read2_b32 v[100:101], v217 offset0:32 offset1:33
    v_mfma_f32_16x16x32_bf16 v[244:247], v[168:171], v[188:191], v[244:247]
    ds_read2_b32 v[102:103], v217 offset0:34 offset1:35
    v_mfma_f32_16x16x32_bf16 v[244:247], v[164:167], v[192:195], v[244:247]
    ds_read_b128 v[132:135], v220 offset:1664
    buffer_load_dwordx4 a[12:15], v2, s[40:43], s23 offen offset:1024 sc1
    v_mfma_f32_16x16x32_bf16 v[244:247], v[160:163], v[196:199], v[244:247]
    ds_read2_b32 v[104:105], v218 offset0:160 offset1:161
    v_mfma_f32_16x16x32_bf16 v[244:247], v[156:159], v[200:203], v[244:247]
    ds_read2_b32 v[106:107], v218 offset0:162 offset1:163
    v_mfma_f32_16x16x32_bf16 v[244:247], v[152:155], v[204:207], v[244:247]
    ds_read_b128 v[136:139], v220 offset:2176
    s_waitcnt lgkmcnt(15)
    v_mfma_f32_16x16x32_bf16 v[248:251], v[176:179], v[184:187], 0
    ds_read2_b32 v[108:109], v218 offset0:32 offset1:33
    v_mfma_f32_16x16x32_bf16 v[248:251], v[172:175], v[188:191], v[248:251]
    ds_read2_b32 v[110:111], v218 offset0:34 offset1:35
    buffer_load_dwordx4 a[16:19], v2, s[40:43], s22 offen offset:2048 sc1
    v_mfma_f32_16x16x32_bf16 v[248:251], v[168:171], v[192:195], v[248:251]
    ds_read_b128 v[140:143], v220 offset:2688
    v_mfma_f32_16x16x32_bf16 v[248:251], v[164:167], v[196:199], v[248:251]
    ds_read2_b32 v[112:113], v219 offset0:160 offset1:161
    v_mfma_f32_16x16x32_bf16 v[248:251], v[160:163], v[200:203], v[248:251]
    ds_read2_b32 v[114:115], v219 offset0:162 offset1:163
    v_mfma_f32_16x16x32_bf16 v[248:251], v[156:159], v[204:207], v[248:251]
    ds_read_b128 v[144:147], v220 offset:3200
    buffer_load_dwordx4 a[20:23], v2, s[40:43], s23 offen offset:2048 sc1
    v_mfma_f32_16x16x32_bf16 v[248:251], v[152:155], v[208:211], v[248:251]
    ds_read2_b32 v[116:117], v219 offset0:32 offset1:33
    v_mfma_f32_16x16x32_bf16 v[252:255], v[180:183], v[184:187], 0
    ds_read2_b32 v[118:119], v219 offset0:34 offset1:35
    v_mfma_f32_16x16x32_bf16 v[252:255], v[176:179], v[188:191], v[252:255]
    ds_read_b128 v[148:151], v220 offset:3712
    v_mfma_f32_16x16x32_bf16 v[252:255], v[172:175], v[192:195], v[252:255]
    v_mfma_f32_16x16x32_bf16 v[252:255], v[168:171], v[196:199], v[252:255]
    buffer_load_dwordx4 a[24:27], v2, s[40:43], s22 offen offset:3072 sc1
    s_add_u32 s22, s22, 4096
    v_mfma_f32_16x16x32_bf16 v[252:255], v[164:167], v[200:203], v[252:255]
    v_mfma_f32_16x16x32_bf16 v[252:255], v[160:163], v[204:207], v[252:255]
    v_mfma_f32_16x16x32_bf16 v[252:255], v[156:159], v[208:211], v[252:255]
    v_mfma_f32_16x16x32_bf16 v[252:255], v[152:155], v[212:215], v[252:255]
    buffer_load_dwordx4 a[28:31], v2, s[40:43], s23 offen offset:3072 sc1
    s_add_u32 s23, s23, 4096
    s_waitcnt vmcnt(8)
    s_barrier
    v_mov_b32 v5, 1
    v_or_b32 v6, s64, v4
    buffer_atomic_add v5, v6, s[40:43], s18 offen sc1
    s_waitcnt lgkmcnt(15)
    v_mfma_f32_16x16x32_bf16 v[224:227], v[88:91], v[120:123], v[224:227]
    v_mfma_f32_16x16x32_bf16 v[228:231], v[92:95], v[120:123], v[228:231]
    v_mfma_f32_16x16x32_bf16 v[228:231], v[88:91], v[124:127], v[228:231]
    v_mfma_f32_16x16x32_bf16 v[232:235], v[96:99], v[120:123], v[232:235]
    v_mfma_f32_16x16x32_bf16 v[232:235], v[92:95], v[124:127], v[232:235]
    buffer_load_dwordx4 a[32:35], v2, s[40:43], s22 offen offset:0 sc1
    v_mfma_f32_16x16x32_bf16 v[232:235], v[88:91], v[128:131], v[232:235]
    s_waitcnt lgkmcnt(12)
    v_mfma_f32_16x16x32_bf16 v[236:239], v[100:103], v[120:123], v[236:239]
    ds_read2_b32 v[152:153], v216 offset0:144 offset1:145
    v_mfma_f32_16x16x32_bf16 v[236:239], v[96:99], v[124:127], v[236:239]
    ds_read2_b32 v[154:155], v216 offset0:146 offset1:147
    v_mfma_f32_16x16x32_bf16 v[236:239], v[92:95], v[128:131], v[236:239]
    ds_read_b128 v[184:187], v220 offset:64
    buffer_load_dwordx4 a[36:39], v2, s[40:43], s23 offen offset:0 sc1
    v_mfma_f32_16x16x32_bf16 v[236:239], v[88:91], v[132:135], v[236:239]
    ds_read2_b32 v[156:157], v216 offset0:16 offset1:17
    s_waitcnt lgkmcnt(13)
    v_mfma_f32_16x16x32_bf16 v[240:243], v[104:107], v[120:123], v[240:243]
    ds_read2_b32 v[158:159], v216 offset0:18 offset1:19
    v_mfma_f32_16x16x32_bf16 v[240:243], v[100:103], v[124:127], v[240:243]
    ds_read_b128 v[188:191], v220 offset:576
    v_mfma_f32_16x16x32_bf16 v[240:243], v[96:99], v[128:131], v[240:243]
    ds_read2_b32 v[160:161], v217 offset0:144 offset1:145
    v_mfma_f32_16x16x32_bf16 v[240:243], v[92:95], v[132:135], v[240:243]
    ds_read2_b32 v[162:163], v217 offset0:146 offset1:147
    buffer_load_dwordx4 a[40:43], v2, s[40:43], s22 offen offset:1024 sc1
    v_mfma_f32_16x16x32_bf16 v[240:243], v[88:91], v[136:139], v[240:243]
    ds_read_b128 v[192:195], v220 offset:1088
    s_waitcnt lgkmcnt(15)
    v_mfma_f32_16x16x32_bf16 v[244:247], v[108:111], v[120:123], v[244:247]
    ds_read2_b32 v[164:165], v217 offset0:16 offset1:17
    v_mfma_f32_16x16x32_bf16 v[244:247], v[104:107], v[124:127], v[244:247]
    ds_read2_b32 v[166:167], v217 offset0:18 offset1:19
    v_mfma_f32_16x16x32_bf16 v[244:247], v[100:103], v[128:131], v[244:247]
    ds_read_b128 v[196:199], v220 offset:1600
    buffer_load_dwordx4 a[44:47], v2, s[40:43], s23 offen offset:1024 sc1
    v_mfma_f32_16x16x32_bf16 v[244:247], v[96:99], v[132:135], v[244:247]
    ds_read2_b32 v[168:169], v218 offset0:144 offset1:145
    v_mfma_f32_16x16x32_bf16 v[244:247], v[92:95], v[136:139], v[244:247]
    ds_read2_b32 v[170:171], v218 offset0:146 offset1:147
    v_mfma_f32_16x16x32_bf16 v[244:247], v[88:91], v[140:143], v[244:247]
    ds_read_b128 v[200:203], v220 offset:2112
    s_waitcnt lgkmcnt(15)
    v_mfma_f32_16x16x32_bf16 v[248:251], v[112:115], v[120:123], v[248:251]
    ds_read2_b32 v[172:173], v218 offset0:16 offset1:17
    v_mfma_f32_16x16x32_bf16 v[248:251], v[108:111], v[124:127], v[248:251]
    ds_read2_b32 v[174:175], v218 offset0:18 offset1:19
    buffer_load_dwordx4 a[48:51], v2, s[40:43], s22 offen offset:2048 sc1
    v_mfma_f32_16x16x32_bf16 v[248:251], v[104:107], v[128:131], v[248:251]
    ds_read_b128 v[204:207], v220 offset:2624
    v_mfma_f32_16x16x32_bf16 v[248:251], v[100:103], v[132:135], v[248:251]
    ds_read2_b32 v[176:177], v219 offset0:144 offset1:145
    v_mfma_f32_16x16x32_bf16 v[248:251], v[96:99], v[136:139], v[248:251]
    ds_read2_b32 v[178:179], v219 offset0:146 offset1:147
    v_mfma_f32_16x16x32_bf16 v[248:251], v[92:95], v[140:143], v[248:251]
    ds_read_b128 v[208:211], v220 offset:3136
    buffer_load_dwordx4 a[52:55], v2, s[40:43], s23 offen offset:2048 sc1
    v_mfma_f32_16x16x32_bf16 v[248:251], v[88:91], v[144:147], v[248:251]
    ds_read2_b32 v[180:181], v219 offset0:16 offset1:17
    v_mfma_f32_16x16x32_bf16 v[252:255], v[116:119], v[120:123], v[252:255]
    ds_read2_b32 v[182:183], v219 offset0:18 offset1:19
    v_mfma_f32_16x16x32_bf16 v[252:255], v[112:115], v[124:127], v[252:255]
    ds_read_b128 v[212:215], v220 offset:3648
    v_mfma_f32_16x16x32_bf16 v[252:255], v[108:111], v[128:131], v[252:255]
    v_mfma_f32_16x16x32_bf16 v[252:255], v[104:107], v[132:135], v[252:255]
    buffer_load_dwordx4 a[56:59], v2, s[40:43], s22 offen offset:3072 sc1
    s_add_u32 s22, s22, 4096
    v_mfma_f32_16x16x32_bf16 v[252:255], v[100:103], v[136:139], v[252:255]
    v_mfma_f32_16x16x32_bf16 v[252:255], v[96:99], v[140:143], v[252:255]
    v_mfma_f32_16x16x32_bf16 v[252:255], v[92:95], v[144:147], v[252:255]
    v_mfma_f32_16x16x32_bf16 v[252:255], v[88:91], v[148:151], v[252:255]
    buffer_load_dwordx4 a[60:63], v2, s[40:43], s23 offen offset:3072 sc1
    s_add_u32 s23, s23, 4096
    s_waitcnt lgkmcnt(15)
    v_mfma_f32_16x16x32_bf16 v[224:227], v[152:155], v[184:187], v[224:227]
    v_mfma_f32_16x16x32_bf16 v[228:231], v[156:159], v[184:187], v[228:231]
    v_mfma_f32_16x16x32_bf16 v[228:231], v[152:155], v[188:191], v[228:231]
    v_mfma_f32_16x16x32_bf16 v[232:235], v[160:163], v[184:187], v[232:235]
    v_mfma_f32_16x16x32_bf16 v[232:235], v[156:159], v[188:191], v[232:235]
    buffer_load_dwordx4 a[64:67], v2, s[40:43], s22 offen offset:0 sc1
    v_mfma_f32_16x16x32_bf16 v[232:235], v[152:155], v[192:195], v[232:235]
    s_waitcnt lgkmcnt(12)
    v_mfma_f32_16x16x32_bf16 v[236:239], v[164:167], v[184:187], v[236:239]
    ds_read2_b32 v[88:89], v216 offset0:128 offset1:129
    v_mfma_f32_16x16x32_bf16 v[236:239], v[160:163], v[188:191], v[236:239]
    ds_read2_b32 v[90:91], v216 offset0:130 offset1:131
    v_mfma_f32_16x16x32_bf16 v[236:239], v[156:159], v[192:195], v[236:239]
    ds_read_b128 v[120:123], v220 offset:0
    buffer_load_dwordx4 a[68:71], v2, s[40:43], s23 offen offset:0 sc1
    v_mfma_f32_16x16x32_bf16 v[236:239], v[152:155], v[196:199], v[236:239]
    ds_read2_b32 v[92:93], v216 offset0:0 offset1:1
    s_waitcnt lgkmcnt(13)
    v_mfma_f32_16x16x32_bf16 v[240:243], v[168:171], v[184:187], v[240:243]
    ds_read2_b32 v[94:95], v216 offset0:2 offset1:3
    v_mfma_f32_16x16x32_bf16 v[240:243], v[164:167], v[188:191], v[240:243]
    ds_read_b128 v[124:127], v220 offset:512
    v_mfma_f32_16x16x32_bf16 v[240:243], v[160:163], v[192:195], v[240:243]
    ds_read2_b32 v[96:97], v217 offset0:128 offset1:129
    v_mfma_f32_16x16x32_bf16 v[240:243], v[156:159], v[196:199], v[240:243]
    ds_read2_b32 v[98:99], v217 offset0:130 offset1:131
    buffer_load_dwordx4 a[72:75], v2, s[40:43], s22 offen offset:1024 sc1
    v_mfma_f32_16x16x32_bf16 v[240:243], v[152:155], v[200:203], v[240:243]
    ds_read_b128 v[128:131], v220 offset:1024
    s_waitcnt lgkmcnt(15)
    v_mfma_f32_16x16x32_bf16 v[244:247], v[172:175], v[184:187], v[244:247]
    ds_read2_b32 v[100:101], v217 offset0:0 offset1:1
    v_mfma_f32_16x16x32_bf16 v[244:247], v[168:171], v[188:191], v[244:247]
    ds_read2_b32 v[102:103], v217 offset0:2 offset1:3
    v_mfma_f32_16x16x32_bf16 v[244:247], v[164:167], v[192:195], v[244:247]
    ds_read_b128 v[132:135], v220 offset:1536
    buffer_load_dwordx4 a[76:79], v2, s[40:43], s23 offen offset:1024 sc1
    v_mfma_f32_16x16x32_bf16 v[244:247], v[160:163], v[196:199], v[244:247]
    ds_read2_b32 v[104:105], v218 offset0:128 offset1:129
    v_mfma_f32_16x16x32_bf16 v[244:247], v[156:159], v[200:203], v[244:247]
    ds_read2_b32 v[106:107], v218 offset0:130 offset1:131
    v_mfma_f32_16x16x32_bf16 v[244:247], v[152:155], v[204:207], v[244:247]
    ds_read_b128 v[136:139], v220 offset:2048
    s_waitcnt lgkmcnt(15)
    v_mfma_f32_16x16x32_bf16 v[248:251], v[176:179], v[184:187], v[248:251]
    ds_read2_b32 v[108:109], v218 offset0:0 offset1:1
    v_mfma_f32_16x16x32_bf16 v[248:251], v[172:175], v[188:191], v[248:251]
    ds_read2_b32 v[110:111], v218 offset0:2 offset1:3
    buffer_load_dwordx4 a[80:83], v2, s[40:43], s22 offen offset:2048 sc1
    v_mfma_f32_16x16x32_bf16 v[248:251], v[168:171], v[192:195], v[248:251]
    ds_read_b128 v[140:143], v220 offset:2560
    v_mfma_f32_16x16x32_bf16 v[248:251], v[164:167], v[196:199], v[248:251]
    ds_read2_b32 v[112:113], v219 offset0:128 offset1:129
    v_mfma_f32_16x16x32_bf16 v[248:251], v[160:163], v[200:203], v[248:251]
    ds_read2_b32 v[114:115], v219 offset0:130 offset1:131
    v_mfma_f32_16x16x32_bf16 v[248:251], v[156:159], v[204:207], v[248:251]
    ds_read_b128 v[144:147], v220 offset:3072
    buffer_load_dwordx4 a[84:87], v2, s[40:43], s23 offen offset:2048 sc1
    v_mfma_f32_16x16x32_bf16 v[248:251], v[152:155], v[208:211], v[248:251]
    ds_read2_b32 v[116:117], v219 offset0:0 offset1:1
    v_mfma_f32_16x16x32_bf16 v[252:255], v[180:183], v[184:187], v[252:255]
    ds_read2_b32 v[118:119], v219 offset0:2 offset1:3
    v_mfma_f32_16x16x32_bf16 v[252:255], v[176:179], v[188:191], v[252:255]
    ds_read_b128 v[148:151], v220 offset:3584
    v_mfma_f32_16x16x32_bf16 v[252:255], v[172:175], v[192:195], v[252:255]
    v_mfma_f32_16x16x32_bf16 v[252:255], v[168:171], v[196:199], v[252:255]
    buffer_load_dwordx4 a[88:91], v2, s[40:43], s22 offen offset:3072 sc1
    s_add_u32 s22, s22, 4096
    v_mfma_f32_16x16x32_bf16 v[252:255], v[164:167], v[200:203], v[252:255]
    v_mfma_f32_16x16x32_bf16 v[252:255], v[160:163], v[204:207], v[252:255]
    v_mfma_f32_16x16x32_bf16 v[252:255], v[156:159], v[208:211], v[252:255]
    v_mfma_f32_16x16x32_bf16 v[252:255], v[152:155], v[212:215], v[252:255]
    buffer_load_dwordx4 a[92:95], v2, s[40:43], s23 offen offset:3072 sc1
    s_add_u32 s23, s23, 4096
    s_waitcnt lgkmcnt(15)
    v_mfma_f32_16x16x32_bf16 v[224:227], v[88:91], v[120:123], v[224:227]
    v_mfma_f32_16x16x32_bf16 v[228:231], v[92:95], v[120:123], v[228:231]
    v_mfma_f32_16x16x32_bf16 v[228:231], v[88:91], v[124:127], v[228:231]
    v_mfma_f32_16x16x32_bf16 v[232:235], v[96:99], v[120:123], v[232:235]
    v_mfma_f32_16x16x32_bf16 v[232:235], v[92:95], v[124:127], v[232:235]
    buffer_load_dwordx4 a[96:99], v2, s[40:43], s22 offen offset:0 sc1
    v_mfma_f32_16x16x32_bf16 v[232:235], v[88:91], v[128:131], v[232:235]
    s_waitcnt lgkmcnt(12)
    v_mfma_f32_16x16x32_bf16 v[236:239], v[100:103], v[120:123], v[236:239]
    v_mfma_f32_16x16x32_bf16 v[236:239], v[96:99], v[124:127], v[236:239]
    v_mfma_f32_16x16x32_bf16 v[236:239], v[92:95], v[128:131], v[236:239]
    buffer_load_dwordx4 a[100:103], v2, s[40:43], s23 offen offset:0 sc1
    v_mfma_f32_16x16x32_bf16 v[236:239], v[88:91], v[132:135], v[236:239]
    s_waitcnt lgkmcnt(9)
    v_mfma_f32_16x16x32_bf16 v[240:243], v[104:107], v[120:123], v[240:243]
    v_mfma_f32_16x16x32_bf16 v[240:243], v[100:103], v[124:127], v[240:243]
    v_mfma_f32_16x16x32_bf16 v[240:243], v[96:99], v[128:131], v[240:243]
    v_mfma_f32_16x16x32_bf16 v[240:243], v[92:95], v[132:135], v[240:243]
    buffer_load_dwordx4 a[104:107], v2, s[40:43], s22 offen offset:1024 sc1
    v_mfma_f32_16x16x32_bf16 v[240:243], v[88:91], v[136:139], v[240:243]
    s_waitcnt lgkmcnt(6)
    v_mfma_f32_16x16x32_bf16 v[244:247], v[108:111], v[120:123], v[244:247]
    v_mfma_f32_16x16x32_bf16 v[244:247], v[104:107], v[124:127], v[244:247]
    v_mfma_f32_16x16x32_bf16 v[244:247], v[100:103], v[128:131], v[244:247]
    buffer_load_dwordx4 a[108:111], v2, s[40:43], s23 offen offset:1024 sc1
    v_mfma_f32_16x16x32_bf16 v[244:247], v[96:99], v[132:135], v[244:247]
    v_mfma_f32_16x16x32_bf16 v[244:247], v[92:95], v[136:139], v[244:247]
    v_mfma_f32_16x16x32_bf16 v[244:247], v[88:91], v[140:143], v[244:247]
    s_waitcnt lgkmcnt(3)
    v_mfma_f32_16x16x32_bf16 v[248:251], v[112:115], v[120:123], v[248:251]
    v_mfma_f32_16x16x32_bf16 v[248:251], v[108:111], v[124:127], v[248:251]
    buffer_load_dwordx4 a[112:115], v2, s[40:43], s22 offen offset:2048 sc1
    v_mfma_f32_16x16x32_bf16 v[248:251], v[104:107], v[128:131], v[248:251]
    v_mfma_f32_16x16x32_bf16 v[248:251], v[100:103], v[132:135], v[248:251]
    v_mfma_f32_16x16x32_bf16 v[248:251], v[96:99], v[136:139], v[248:251]
    v_mfma_f32_16x16x32_bf16 v[248:251], v[92:95], v[140:143], v[248:251]
    buffer_load_dwordx4 a[116:119], v2, s[40:43], s23 offen offset:2048 sc1
    v_mfma_f32_16x16x32_bf16 v[248:251], v[88:91], v[144:147], v[248:251]
    s_waitcnt lgkmcnt(0)
    v_mfma_f32_16x16x32_bf16 v[252:255], v[116:119], v[120:123], v[252:255]
    v_mfma_f32_16x16x32_bf16 v[252:255], v[112:115], v[124:127], v[252:255]
    v_mfma_f32_16x16x32_bf16 v[252:255], v[108:111], v[128:131], v[252:255]
    v_mfma_f32_16x16x32_bf16 v[252:255], v[104:107], v[132:135], v[252:255]
    buffer_load_dwordx4 a[120:123], v2, s[40:43], s22 offen offset:3072 sc1
    s_add_u32 s22, s22, 4096
    v_mfma_f32_16x16x32_bf16 v[252:255], v[100:103], v[136:139], v[252:255]
    v_mfma_f32_16x16x32_bf16 v[252:255], v[96:99], v[140:143], v[252:255]
    v_mfma_f32_16x16x32_bf16 v[252:255], v[92:95], v[144:147], v[252:255]
    v_mfma_f32_16x16x32_bf16 v[252:255], v[88:91], v[148:151], v[252:255]
    buffer_load_dwordx4 a[124:127], v2, s[40:43], s23 offen offset:3072 sc1
    s_add_u32 s23, s23, 4096
    ds_write_b128 v221, v[224:227] offset:0
    ds_write_b128 v221, v[228:231] offset:1024
    ds_write_b128 v221, v[232:235] offset:2048
    ds_write_b128 v221, v[236:239] offset:3072
    ds_write_b128 v221, v[240:243] offset:4096
    ds_write_b128 v221, v[244:247] offset:5120
    ds_write_b128 v221, v[248:251] offset:6144
    ds_write_b128 v221, v[252:255] offset:7168
    s_waitcnt lgkmcnt(0)
    s_barrier
    s_lshl_b32 s18, s83, 8
    s_and_b32 s4, s2, 7
    s_lshl_b32 s4, s4, 12
    s_add_u32 s18, s18, s4
    s_add_u32 s18, s18, 425984
    v_mov_b32 v16, 0
    ds_read_b128 v[88:91], v222 offset:0
    ds_read_b128 v[92:95], v222 offset:8192
    ds_read_b128 v[96:99], v222 offset:16384
    ds_read_b128 v[100:103], v222 offset:24576
    ds_read_b128 v[104:107], v222 offset:4096
    ds_read_b128 v[108:111], v222 offset:12288
    ds_read_b128 v[112:115], v222 offset:20480
    ds_read_b128 v[116:119], v222 offset:28672
    s_mul_i32 s4, s2, 8448
    s_add_u32 s4, s4, 4194304
    s_add_u32 s5, s4, 4096
    s_waitcnt lgkmcnt(6)
    v_pk_add_f32 v[88:89], v[88:89], v[92:93]
    v_pk_add_f32 v[90:91], v[90:91], v[94:95]
    v_pk_fma_f32 v[72:73], v[88:89], s[78:79], v[72:73] op_sel:[0,1,0] op_sel_hi:[1,1,1]
    v_pk_fma_f32 v[74:75], v[90:91], s[78:79], v[74:75] op_sel:[0,1,0] op_sel_hi:[1,1,1]
    s_waitcnt lgkmcnt(4)
    v_pk_add_f32 v[96:97], v[96:97], v[100:101]
    v_pk_add_f32 v[98:99], v[98:99], v[102:103]
    v_pk_fma_f32 v[80:81], v[96:97], s[80:81], v[80:81] op_sel:[0,1,0] op_sel_hi:[1,1,1]
    v_pk_fma_f32 v[82:83], v[98:99], s[80:81], v[82:83] op_sel:[0,1,0] op_sel_hi:[1,1,1]
    v_cvt_pk_bf16_f32 v8, v72, v80
    v_cvt_pk_bf16_f32 v9, v73, v81
    v_cvt_pk_bf16_f32 v10, v74, v82
    v_cvt_pk_bf16_f32 v11, v75, v83
    buffer_store_dwordx4 v[8:11], v1, s[40:43], s4 offen sc1
    s_waitcnt lgkmcnt(2)
    v_pk_add_f32 v[104:105], v[104:105], v[108:109]
    v_pk_add_f32 v[106:107], v[106:107], v[110:111]
    v_pk_fma_f32 v[76:77], v[104:105], s[78:79], v[76:77] op_sel:[0,1,0] op_sel_hi:[1,1,1]
    v_pk_fma_f32 v[78:79], v[106:107], s[78:79], v[78:79] op_sel:[0,1,0] op_sel_hi:[1,1,1]
    s_waitcnt lgkmcnt(0)
    v_pk_add_f32 v[112:113], v[112:113], v[116:117]
    v_pk_add_f32 v[114:115], v[114:115], v[118:119]
    v_pk_fma_f32 v[84:85], v[112:113], s[80:81], v[84:85] op_sel:[0,1,0] op_sel_hi:[1,1,1]
    v_pk_fma_f32 v[86:87], v[114:115], s[80:81], v[86:87] op_sel:[0,1,0] op_sel_hi:[1,1,1]
    v_cvt_pk_bf16_f32 v12, v76, v84
    v_cvt_pk_bf16_f32 v13, v77, v85
    v_cvt_pk_bf16_f32 v14, v78, v86
    v_cvt_pk_bf16_f32 v15, v79, v87
    buffer_store_dwordx4 v[12:15], v1, s[40:43], s5 offen sc1
    s_mul_i32 s12, s83, 229376
    s_add_u32 s12, s12, 8388608
    s_mul_i32 s11, s3, 15360
    s_add_u32 s11, s11, 98304
    s_lshl_b32 s14, s3, 13
    v_add_u32 v118, s14, v2
    s_mul_i32 s4, s83, 896
    s_lshl_b32 s5, s3, 8
    s_add_u32 s4, s4, 262144
    s_add_u32 s5, s5, 159744
    v_lshlrev_b32 v5, 2, v0
    v_mov_b32 v6, 1073741824
    v_cmp_gt_u32 vcc, 896, v5
    s_nop 1
    v_cndmask_b32 v5, v6, v5, vcc
    v_add_u32 v114, 0x10000, v2
    v_add_u32 v120, 98304, v2
    v_bfe_u32 v6, v0, 3, 3
    v_and_b32 v7, 0x70, v2
    s_movk_i32 s7, 8448
    v_mad_u32_u24 v117, v6, s7, v7
    v_and_b32 v6, 31, v0
    v_bfe_u32 v7, v0, 5, 1
    v_lshl_add_u32 v6, v6, 2, s11
    v_lshl_add_u32 v115, v7, 9, v6
    v_add_u32 v116, 128, v115
    v_lshlrev_b32 v7, 6, v7
    v_add_u32 v119, 159744, v7
    s_lshl_b32 s10, s82, 9
    s_lshl_b32 s7, s3, 7
    s_add_u32 s10, s10, s7
    s_add_u32 s10, s10, 4194304
    s_lshl_b32 s13, s82, 2
    s_add_u32 s13, s13, s3
    s_mul_i32 s13, s13, 112
    s_mul_i32 s7, s83, 7
    s_add_u32 s13, s13, s7
    s_lshl_b32 s13, s13, 10
    s_add_u32 s13, s13, 16777216
    s_buffer_load_dword s21, s[40:43], s18 glc
    s_mov_b32 s20, s4
    s_mov_b32 m0, s5
    s_mov_b32 s16, s18
    s_and_b32 s4, s2, 15
    s_lshl_b32 s4, s4, 8
    s_add_u32 s4, s4, 3670016
    v_mov_b32 v6, 1
    s_mov_b32 s17, 4096
    v_mul_lo_u32 v18, v0, s17
    v_mov_b32 v19, 1073741824
    v_cmp_gt_u32 vcc, 8, v0
    s_nop 1
    v_cndmask_b32 v18, v19, v18, vcc
    s_and_b32 s6, s2, 7
    s_lshl_b32 s6, s6, 2
    s_add_u32 s6, s6, s3
    s_mul_i32 s17, s6, 1024
    s_add_u32 s17, s17, 3670016
    v_lshlrev_b32 v19, 4, v2
    s_lshr_b32 s9, s3, 1
    s_lshl_b32 s6, s85, 1
    s_add_u32 s6, s6, s9
    s_lshl_b32 s7, s82, 1
    s_add_u32 s7, s7, s9
    s_lshl_b32 s7, s7, 13
    s_lshr_b32 s9, s83, 2
    s_lshl_b32 s9, s9, 7
    s_add_u32 s7, s7, s9
    s_add_u32 s81, s7, 786432
    s_lshl_b32 s7, s84, 3
    s_add_u32 s7, s7, s85
    s_lshl_b32 s7, s7, 3
    s_add_u32 s7, s7, s3
    s_lshl_b32 s7, s7, 7
    s_add_u32 s15, s7, 786432
    v_mov_b32 v121, 1073741824
    v_lshlrev_b32 v7, 6, v2
    v_cmp_gt_u32 vcc, 128, v2
    s_nop 1
    v_cndmask_b32 v7, v121, v7, vcc
    v_mov_b32 v121, 1
    s_and_b32 s9, s3, 1
    s_lshl_b32 s7, s84, 1
    s_add_u32 s7, s7, s9
    s_mul_i32 s9, s6, 135168
    s_lshl_b32 s5, s7, 7
    s_add_u32 s9, s9, s5
    s_add_u32 s18, s9, 4194304
    s_lshl_b32 s8, s7, 15
    s_lshl_b32 s5, s6, 6
    s_add_u32 s8, s8, s5
    s_mul_i32 s5, s3, 28672
    s_add_u32 s5, s5, 16777216
    s_mul_i32 s24, s7, 114688
    s_add_u32 s24, s24, s5
    s_xor_b32 s7, s7, 1
    s_mul_i32 s74, s7, 114688
    s_add_u32 s74, s74, s5
    s_add_u32 s25, s24, 4096
    s_add_u32 s75, s74, 4096
    s_add_u32 s26, s24, 8192
    s_add_u32 s76, s74, 8192
    s_add_u32 s27, s24, 12288
    s_add_u32 s77, s74, 12288
    s_add_u32 s28, s24, 16384
    s_add_u32 s78, s74, 16384
    s_add_u32 s29, s24, 20480
    s_add_u32 s79, s74, 20480
    s_add_u32 s30, s24, 24576
    s_add_u32 s80, s74, 24576
    s_waitcnt vmcnt(0)
    s_barrier
    buffer_atomic_add v6, v18, s[40:43], s4 offen sc1
    s_waitcnt lgkmcnt(0)
    s_cmp_eq_u32 s21, 14
    s_cbranch_scc1 Lwrok
    s_mov_b64 exec, 1
    s_mov_b32 s86, 0
Lwr:
    buffer_load_dword v17, v16, s[40:43], s16 offen sc1
    s_add_u32 s86, s86, 1
    s_waitcnt vmcnt(0)
    v_cmp_ne_u32 vcc, 14, v17
    s_cmp_gt_u32 s86, 200000
    s_cbranch_scc1 Lwrx
    s_cbranch_vccnz Lwr
Lwrx:
    s_mov_b64 exec, -1
Lwrok:
    buffer_load_dword v5, s[40:43], s20 offen sc1 lds
    s_lshl_b32 s5, s3, 12
    s_add_u32 s5, s5, 0
    s_add_u32 s4, s12, s5
Lb2l:
    s_mov_b32 m0, s5
    s_add_u32 s5, s5, 16384
    buffer_load_dwordx4 v2, s[40:43], s4 offen offset:0 sc1 lds
    buffer_load_dwordx4 v2, s[40:43], s4 offen offset:1024 sc1 lds
    buffer_load_dwordx4 v2, s[40:43], s4 offen offset:2048 sc1 lds
    buffer_load_dwordx4 v2, s[40:43], s4 offen offset:3072 sc1 lds
    s_add_u32 s4, s4, 16384
    s_cmp_lt_u32 s5, 65536
    s_cbranch_scc1 Lb2l
Lb2e:
    s_waitcnt vmcnt(0)
    s_cmp_lg_u32 s3, 0
    s_cbranch_scc1 Lb2z
    s_mov_b64 exec, 65535
    s_mov_b32 s86, 0
Lb2:
    buffer_load_dword v6, v19, s[40:43], s17 offen sc1
    s_add_u32 s86, s86, 1
    s_waitcnt vmcnt(0)
    v_cmp_ne_u32 vcc, 16, v6
    s_cmp_gt_u32 s86, 200000
    s_cbranch_scc1 Lb2x
    s_cbranch_vccnz Lb2
Lb2x:
    s_mov_b64 exec, -1
Lb2z:
    s_waitcnt vmcnt(0)
    s_barrier
    s_add_u32 m0, s11, 0
    s_nop 0
    buffer_load_dwordx4 v117, s[40:43], s10 offen sc1 lds
    s_add_u32 m0, s11, 1024
    s_add_u32 s10, s10, 67584
    buffer_load_dwordx4 v117, s[40:43], s10 offen sc1 lds
    s_add_u32 m0, s11, 2048
    s_add_u32 s10, s10, 67584
    buffer_load_dwordx4 v117, s[40:43], s10 offen sc1 lds
    s_add_u32 m0, s11, 3072
    s_add_u32 s10, s10, 67584
    buffer_load_dwordx4 v117, s[40:43], s10 offen sc1 lds
    s_add_u32 m0, s11, 4096
    s_add_u32 s10, s10, 67584
    buffer_load_dwordx4 v117, s[40:43], s10 offen sc1 lds
    s_add_u32 m0, s11, 5120
    s_add_u32 s10, s10, 67584
    buffer_load_dwordx4 v117, s[40:43], s10 offen sc1 lds
    s_add_u32 m0, s11, 6144
    s_add_u32 s10, s10, 67584
    buffer_load_dwordx4 v117, s[40:43], s10 offen sc1 lds
    s_add_u32 m0, s11, 7168
    s_add_u32 s10, s10, 67584
    buffer_load_dwordx4 v117, s[40:43], s10 offen sc1 lds
    s_add_u32 m0, s11, 8192
    s_add_u32 s10, s10, 67584
    buffer_load_dwordx4 v117, s[40:43], s10 offen sc1 lds
    s_add_u32 m0, s11, 9216
    s_add_u32 s10, s10, 67584
    buffer_load_dwordx4 v117, s[40:43], s10 offen sc1 lds
    s_add_u32 m0, s11, 10240
    s_add_u32 s10, s10, 67584
    buffer_load_dwordx4 v117, s[40:43], s10 offen sc1 lds
    s_add_u32 m0, s11, 11264
    s_add_u32 s10, s10, 67584
    buffer_load_dwordx4 v117, s[40:43], s10 offen sc1 lds
    s_add_u32 m0, s11, 12288
    s_add_u32 s10, s10, 67584
    buffer_load_dwordx4 v117, s[40:43], s10 offen sc1 lds
    s_add_u32 m0, s11, 13312
    s_add_u32 s10, s10, 67584
    buffer_load_dwordx4 v117, s[40:43], s10 offen sc1 lds
    s_add_u32 m0, s11, 14336
    s_add_u32 s10, s10, 67584
    buffer_load_dwordx4 v117, s[40:43], s10 offen sc1 lds
    v_mov_b32 v122, s73
    v_mov_b32 v123, s73
    s_waitcnt vmcnt(14)
    ds_read2st64_b32 v[128:129], v115 offset0:0 offset1:1
    ds_read2st64_b32 v[130:131], v116 offset0:0 offset1:1
    ds_read_b128 v[40:43], v2 offset:0
    ds_read_b128 v[44:47], v2 offset:32768
    s_waitcnt vmcnt(13)
    ds_read2st64_b32 v[132:133], v115 offset0:4 offset1:5
    ds_read2st64_b32 v[134:135], v116 offset0:4 offset1:5
    ds_read_b128 v[48:51], v2 offset:1024
    ds_read_b128 v[52:55], v2 offset:33792
    s_waitcnt lgkmcnt(4)
    v_mfma_f32_32x32x16_bf16 v[8:23], v[40:43], v[128:131], 0
    s_add_u32 m0, s11, 0
    s_add_u32 s10, s10, 67584
    buffer_load_dwordx4 v117, s[40:43], s10 offen sc1 lds
    v_mfma_f32_4x4x4_16b_bf16 v[100:103], v[128:129], v[128:129], 0
    v_mfma_f32_4x4x4_16b_bf16 v[104:107], v[122:123], v[128:129], 0
    v_mfma_f32_32x32x16_bf16 v[24:39], v[44:47], v[128:131], 0
    s_waitcnt vmcnt(13)
    ds_read2st64_b32 v[136:137], v115 offset0:8 offset1:9
    ds_read2st64_b32 v[138:139], v116 offset0:8 offset1:9
    ds_read_b128 v[56:59], v2 offset:2048
    ds_read_b128 v[60:63], v2 offset:34816
    v_mfma_f32_4x4x4_16b_bf16 v[100:103], v[130:131], v[130:131], v[100:103]
    v_mfma_f32_4x4x4_16b_bf16 v[104:107], v[122:123], v[130:131], v[104:107]
    s_waitcnt lgkmcnt(4)
    v_mfma_f32_32x32x16_bf16 v[8:23], v[48:51], v[132:135], v[8:23]
    s_add_u32 m0, s11, 1024
    s_add_u32 s10, s10, 67584
    buffer_load_dwordx4 v117, s[40:43], s10 offen sc1 lds
    v_mfma_f32_4x4x4_16b_bf16 v[100:103], v[132:133], v[132:133], v[100:103]
    v_mfma_f32_4x4x4_16b_bf16 v[104:107], v[122:123], v[132:133], v[104:107]
    v_mfma_f32_32x32x16_bf16 v[24:39], v[52:55], v[132:135], v[24:39]
    s_waitcnt vmcnt(13)
    ds_read2st64_b32 v[140:141], v115 offset0:12 offset1:13
    ds_read2st64_b32 v[142:143], v116 offset0:12 offset1:13
    ds_read_b128 v[40:43], v2 offset:3072
    ds_read_b128 v[44:47], v2 offset:35840
    v_mfma_f32_4x4x4_16b_bf16 v[100:103], v[134:135], v[134:135], v[100:103]
    v_mfma_f32_4x4x4_16b_bf16 v[104:107], v[122:123], v[134:135], v[104:107]
    s_waitcnt lgkmcnt(4)
    v_mfma_f32_32x32x16_bf16 v[8:23], v[56:59], v[136:139], v[8:23]
    s_add_u32 m0, s11, 2048
    s_add_u32 s10, s10, 67584
    buffer_load_dwordx4 v117, s[40:43], s10 offen sc1 lds
    v_mfma_f32_4x4x4_16b_bf16 v[100:103], v[136:137], v[136:137], v[100:103]
    v_mfma_f32_4x4x4_16b_bf16 v[104:107], v[122:123], v[136:137], v[104:107]
    v_mfma_f32_32x32x16_bf16 v[24:39], v[60:63], v[136:139], v[24:39]
    s_waitcnt vmcnt(13)
    ds_read2st64_b32 v[144:145], v115 offset0:16 offset1:17
    ds_read2st64_b32 v[146:147], v116 offset0:16 offset1:17
    ds_read_b128 v[48:51], v2 offset:4096
    ds_read_b128 v[52:55], v2 offset:36864
    v_mfma_f32_4x4x4_16b_bf16 v[100:103], v[138:139], v[138:139], v[100:103]
    v_mfma_f32_4x4x4_16b_bf16 v[104:107], v[122:123], v[138:139], v[104:107]
    s_waitcnt lgkmcnt(4)
    v_mfma_f32_32x32x16_bf16 v[8:23], v[40:43], v[140:143], v[8:23]
    s_add_u32 m0, s11, 3072
    s_add_u32 s10, s10, 67584
    buffer_load_dwordx4 v117, s[40:43], s10 offen sc1 lds
    v_mfma_f32_4x4x4_16b_bf16 v[100:103], v[140:141], v[140:141], v[100:103]
    v_mfma_f32_4x4x4_16b_bf16 v[104:107], v[122:123], v[140:141], v[104:107]
    v_mfma_f32_32x32x16_bf16 v[24:39], v[44:47], v[140:143], v[24:39]
    s_waitcnt vmcnt(13)
    ds_read2st64_b32 v[148:149], v115 offset0:20 offset1:21
    ds_read2st64_b32 v[150:151], v116 offset0:20 offset1:21
    ds_read_b128 v[56:59], v2 offset:5120
    ds_read_b128 v[60:63], v2 offset:37888
    v_mfma_f32_4x4x4_16b_bf16 v[100:103], v[142:143], v[142:143], v[100:103]
    v_mfma_f32_4x4x4_16b_bf16 v[104:107], v[122:123], v[142:143], v[104:107]
    s_waitcnt lgkmcnt(4)
    v_mfma_f32_32x32x16_bf16 v[8:23], v[48:51], v[144:147], v[8:23]
    s_add_u32 m0, s11, 4096
    s_add_u32 s10, s10, 67584
    buffer_load_dwordx4 v117, s[40:43], s10 offen sc1 lds
    v_mfma_f32_4x4x4_16b_bf16 v[100:103], v[144:145], v[144:145], v[100:103]
    v_mfma_f32_4x4x4_16b_bf16 v[104:107], v[122:123], v[144:145], v[104:107]
    v_mfma_f32_32x32x16_bf16 v[24:39], v[52:55], v[144:147], v[24:39]
    s_waitcnt vmcnt(13)
    ds_read2st64_b32 v[152:153], v115 offset0:24 offset1:25
    ds_read2st64_b32 v[154:155], v116 offset0:24 offset1:25
    ds_read_b128 v[40:43], v2 offset:6144
    ds_read_b128 v[44:47], v2 offset:38912
    v_mfma_f32_4x4x4_16b_bf16 v[100:103], v[146:147], v[146:147], v[100:103]
    v_mfma_f32_4x4x4_16b_bf16 v[104:107], v[122:123], v[146:147], v[104:107]
    s_waitcnt lgkmcnt(4)
    v_mfma_f32_32x32x16_bf16 v[8:23], v[56:59], v[148:151], v[8:23]
    s_add_u32 m0, s11, 5120
    s_add_u32 s10, s10, 67584
    buffer_load_dwordx4 v117, s[40:43], s10 offen sc1 lds
    v_mfma_f32_4x4x4_16b_bf16 v[100:103], v[148:149], v[148:149], v[100:103]
    v_mfma_f32_4x4x4_16b_bf16 v[104:107], v[122:123], v[148:149], v[104:107]
    v_mfma_f32_32x32x16_bf16 v[24:39], v[60:63], v[148:151], v[24:39]
    s_waitcnt vmcnt(13)
    ds_read2st64_b32 v[156:157], v115 offset0:28 offset1:29
    ds_read2st64_b32 v[158:159], v116 offset0:28 offset1:29
    ds_read_b128 v[48:51], v2 offset:7168
    ds_read_b128 v[52:55], v2 offset:39936
    v_mfma_f32_4x4x4_16b_bf16 v[100:103], v[150:151], v[150:151], v[100:103]
    v_mfma_f32_4x4x4_16b_bf16 v[104:107], v[122:123], v[150:151], v[104:107]
    s_waitcnt lgkmcnt(4)
    v_mfma_f32_32x32x16_bf16 v[8:23], v[40:43], v[152:155], v[8:23]
    s_add_u32 m0, s11, 6144
    s_add_u32 s10, s10, 67584
    buffer_load_dwordx4 v117, s[40:43], s10 offen sc1 lds
    v_mfma_f32_4x4x4_16b_bf16 v[100:103], v[152:153], v[152:153], v[100:103]
    v_mfma_f32_4x4x4_16b_bf16 v[104:107], v[122:123], v[152:153], v[104:107]
    v_mfma_f32_32x32x16_bf16 v[24:39], v[44:47], v[152:155], v[24:39]
    s_waitcnt vmcnt(13)
    ds_read2st64_b32 v[160:161], v115 offset0:32 offset1:33
    ds_read2st64_b32 v[162:163], v116 offset0:32 offset1:33
    ds_read_b128 v[56:59], v2 offset:8192
    ds_read_b128 v[60:63], v2 offset:40960
    v_mfma_f32_4x4x4_16b_bf16 v[100:103], v[154:155], v[154:155], v[100:103]
    v_mfma_f32_4x4x4_16b_bf16 v[104:107], v[122:123], v[154:155], v[104:107]
    s_waitcnt lgkmcnt(4)
    v_mfma_f32_32x32x16_bf16 v[8:23], v[48:51], v[156:159], v[8:23]
    s_add_u32 m0, s11, 7168
    s_add_u32 s10, s10, 67584
    buffer_load_dwordx4 v117, s[40:43], s10 offen sc1 lds
    v_mfma_f32_4x4x4_16b_bf16 v[100:103], v[156:157], v[156:157], v[100:103]
    v_mfma_f32_4x4x4_16b_bf16 v[104:107], v[122:123], v[156:157], v[104:107]
    v_mfma_f32_32x32x16_bf16 v[24:39], v[52:55], v[156:159], v[24:39]
    s_waitcnt vmcnt(13)
    ds_read2st64_b32 v[164:165], v115 offset0:36 offset1:37
    ds_read2st64_b32 v[166:167], v116 offset0:36 offset1:37
    ds_read_b128 v[40:43], v2 offset:9216
    ds_read_b128 v[44:47], v2 offset:41984
    v_mfma_f32_4x4x4_16b_bf16 v[100:103], v[158:159], v[158:159], v[100:103]
    v_mfma_f32_4x4x4_16b_bf16 v[104:107], v[122:123], v[158:159], v[104:107]
    s_waitcnt lgkmcnt(4)
    v_mfma_f32_32x32x16_bf16 v[8:23], v[56:59], v[160:163], v[8:23]
    s_add_u32 m0, s11, 8192
    s_add_u32 s10, s10, 67584
    buffer_load_dwordx4 v117, s[40:43], s10 offen sc1 lds
    v_mfma_f32_4x4x4_16b_bf16 v[100:103], v[160:161], v[160:161], v[100:103]
    v_mfma_f32_4x4x4_16b_bf16 v[104:107], v[122:123], v[160:161], v[104:107]
    v_mfma_f32_32x32x16_bf16 v[24:39], v[60:63], v[160:163], v[24:39]
    s_waitcnt vmcnt(13)
    ds_read2st64_b32 v[168:169], v115 offset0:40 offset1:41
    ds_read2st64_b32 v[170:171], v116 offset0:40 offset1:41
    ds_read_b128 v[48:51], v2 offset:10240
    ds_read_b128 v[52:55], v2 offset:43008
    v_mfma_f32_4x4x4_16b_bf16 v[100:103], v[162:163], v[162:163], v[100:103]
    v_mfma_f32_4x4x4_16b_bf16 v[104:107], v[122:123], v[162:163], v[104:107]
    s_waitcnt lgkmcnt(4)
    v_mfma_f32_32x32x16_bf16 v[8:23], v[40:43], v[164:167], v[8:23]
    s_add_u32 m0, s11, 9216
    s_add_u32 s10, s10, 67584
    buffer_load_dwordx4 v117, s[40:43], s10 offen sc1 lds
    v_mfma_f32_4x4x4_16b_bf16 v[100:103], v[164:165], v[164:165], v[100:103]
    v_mfma_f32_4x4x4_16b_bf16 v[104:107], v[122:123], v[164:165], v[104:107]
    v_mfma_f32_32x32x16_bf16 v[24:39], v[44:47], v[164:167], v[24:39]
    s_waitcnt vmcnt(13)
    ds_read2st64_b32 v[172:173], v115 offset0:44 offset1:45
    ds_read2st64_b32 v[174:175], v116 offset0:44 offset1:45
    ds_read_b128 v[56:59], v2 offset:11264
    ds_read_b128 v[60:63], v2 offset:44032
    v_mfma_f32_4x4x4_16b_bf16 v[100:103], v[166:167], v[166:167], v[100:103]
    v_mfma_f32_4x4x4_16b_bf16 v[104:107], v[122:123], v[166:167], v[104:107]
    s_waitcnt lgkmcnt(4)
    v_mfma_f32_32x32x16_bf16 v[8:23], v[48:51], v[168:171], v[8:23]
    s_add_u32 m0, s11, 10240
    s_add_u32 s10, s10, 67584
    buffer_load_dwordx4 v117, s[40:43], s10 offen sc1 lds
    v_mfma_f32_4x4x4_16b_bf16 v[100:103], v[168:169], v[168:169], v[100:103]
    v_mfma_f32_4x4x4_16b_bf16 v[104:107], v[122:123], v[168:169], v[104:107]
    v_mfma_f32_32x32x16_bf16 v[24:39], v[52:55], v[168:171], v[24:39]
    s_waitcnt vmcnt(13)
    ds_read2st64_b32 v[176:177], v115 offset0:48 offset1:49
    ds_read2st64_b32 v[178:179], v116 offset0:48 offset1:49
    ds_read_b128 v[40:43], v2 offset:12288
    ds_read_b128 v[44:47], v2 offset:45056
    v_mfma_f32_4x4x4_16b_bf16 v[100:103], v[170:171], v[170:171], v[100:103]
    v_mfma_f32_4x4x4_16b_bf16 v[104:107], v[122:123], v[170:171], v[104:107]
    s_waitcnt lgkmcnt(4)
    v_mfma_f32_32x32x16_bf16 v[8:23], v[56:59], v[172:175], v[8:23]
    s_add_u32 m0, s11, 11264
    s_add_u32 s10, s10, 67584
    buffer_load_dwordx4 v117, s[40:43], s10 offen sc1 lds
    v_mfma_f32_4x4x4_16b_bf16 v[100:103], v[172:173], v[172:173], v[100:103]
    v_mfma_f32_4x4x4_16b_bf16 v[104:107], v[122:123], v[172:173], v[104:107]
    v_mfma_f32_32x32x16_bf16 v[24:39], v[60:63], v[172:175], v[24:39]
    s_waitcnt vmcnt(13)
    ds_read2st64_b32 v[180:181], v115 offset0:52 offset1:53
    ds_read2st64_b32 v[182:183], v116 offset0:52 offset1:53
    ds_read_b128 v[48:51], v2 offset:13312
    ds_read_b128 v[52:55], v2 offset:46080
    v_mfma_f32_4x4x4_16b_bf16 v[100:103], v[174:175], v[174:175], v[100:103]
    v_mfma_f32_4x4x4_16b_bf16 v[104:107], v[122:123], v[174:175], v[104:107]
    s_waitcnt lgkmcnt(4)
    v_mfma_f32_32x32x16_bf16 v[8:23], v[40:43], v[176:179], v[8:23]
    s_add_u32 m0, s11, 12288
    s_add_u32 s10, s10, 67584
    buffer_load_dwordx4 v117, s[40:43], s10 offen sc1 lds
    v_mfma_f32_4x4x4_16b_bf16 v[100:103], v[176:177], v[176:177], v[100:103]
    v_mfma_f32_4x4x4_16b_bf16 v[104:107], v[122:123], v[176:177], v[104:107]
    v_mfma_f32_32x32x16_bf16 v[24:39], v[44:47], v[176:179], v[24:39]
    s_waitcnt vmcnt(13)
    ds_read2st64_b32 v[184:185], v115 offset0:56 offset1:57
    ds_read2st64_b32 v[186:187], v116 offset0:56 offset1:57
    ds_read_b128 v[56:59], v2 offset:14336
    ds_read_b128 v[60:63], v2 offset:47104
    v_mfma_f32_4x4x4_16b_bf16 v[100:103], v[178:179], v[178:179], v[100:103]
    v_mfma_f32_4x4x4_16b_bf16 v[104:107], v[122:123], v[178:179], v[104:107]
    s_waitcnt lgkmcnt(4)
    v_mfma_f32_32x32x16_bf16 v[8:23], v[48:51], v[180:183], v[8:23]
    s_add_u32 m0, s11, 13312
    s_add_u32 s10, s10, 67584
    buffer_load_dwordx4 v117, s[40:43], s10 offen sc1 lds
    v_mfma_f32_4x4x4_16b_bf16 v[100:103], v[180:181], v[180:181], v[100:103]
    v_mfma_f32_4x4x4_16b_bf16 v[104:107], v[122:123], v[180:181], v[104:107]
    v_mfma_f32_32x32x16_bf16 v[24:39], v[52:55], v[180:183], v[24:39]
    s_waitcnt vmcnt(13)
    ds_read2st64_b32 v[188:189], v115 offset0:0 offset1:1
    ds_read2st64_b32 v[190:191], v116 offset0:0 offset1:1
    ds_read_b128 v[40:43], v2 offset:15360
    ds_read_b128 v[44:47], v2 offset:48128
    v_mfma_f32_4x4x4_16b_bf16 v[100:103], v[182:183], v[182:183], v[100:103]
    v_mfma_f32_4x4x4_16b_bf16 v[104:107], v[122:123], v[182:183], v[104:107]
    s_waitcnt lgkmcnt(4)
    v_mfma_f32_32x32x16_bf16 v[8:23], v[56:59], v[184:187], v[8:23]
    s_add_u32 m0, s11, 14336
    s_add_u32 s10, s10, 67584
    buffer_load_dwordx4 v117, s[40:43], s10 offen sc1 lds
    v_mfma_f32_4x4x4_16b_bf16 v[100:103], v[184:185], v[184:185], v[100:103]
    v_mfma_f32_4x4x4_16b_bf16 v[104:107], v[122:123], v[184:185], v[104:107]
    v_mfma_f32_32x32x16_bf16 v[24:39], v[60:63], v[184:187], v[24:39]
    s_waitcnt vmcnt(13)
    ds_read2st64_b32 v[192:193], v115 offset0:4 offset1:5
    ds_read2st64_b32 v[194:195], v116 offset0:4 offset1:5
    ds_read_b128 v[48:51], v2 offset:16384
    ds_read_b128 v[52:55], v2 offset:49152
    v_mfma_f32_4x4x4_16b_bf16 v[100:103], v[186:187], v[186:187], v[100:103]
    v_mfma_f32_4x4x4_16b_bf16 v[104:107], v[122:123], v[186:187], v[104:107]
    s_waitcnt lgkmcnt(4)
    v_mfma_f32_32x32x16_bf16 v[8:23], v[40:43], v[188:191], v[8:23]
    s_add_u32 m0, s11, 0
    s_add_u32 s10, s10, 67584
    buffer_load_dwordx4 v117, s[40:43], s10 offen sc1 lds
    v_mfma_f32_4x4x4_16b_bf16 v[100:103], v[188:189], v[188:189], v[100:103]
    v_mfma_f32_4x4x4_16b_bf16 v[104:107], v[122:123], v[188:189], v[104:107]
    v_mfma_f32_32x32x16_bf16 v[24:39], v[44:47], v[188:191], v[24:39]
    s_waitcnt vmcnt(13)
    ds_read2st64_b32 v[196:197], v115 offset0:8 offset1:9
    ds_read2st64_b32 v[198:199], v116 offset0:8 offset1:9
    ds_read_b128 v[56:59], v2 offset:17408
    ds_read_b128 v[60:63], v2 offset:50176
    v_mfma_f32_4x4x4_16b_bf16 v[100:103], v[190:191], v[190:191], v[100:103]
    v_mfma_f32_4x4x4_16b_bf16 v[104:107], v[122:123], v[190:191], v[104:107]
    s_waitcnt lgkmcnt(4)
    v_mfma_f32_32x32x16_bf16 v[8:23], v[48:51], v[192:195], v[8:23]
    s_add_u32 m0, s11, 1024
    s_add_u32 s10, s10, 67584
    buffer_load_dwordx4 v117, s[40:43], s10 offen sc1 lds
    v_mfma_f32_4x4x4_16b_bf16 v[100:103], v[192:193], v[192:193], v[100:103]
    v_mfma_f32_4x4x4_16b_bf16 v[104:107], v[122:123], v[192:193], v[104:107]
    v_mfma_f32_32x32x16_bf16 v[24:39], v[52:55], v[192:195], v[24:39]
    s_waitcnt vmcnt(13)
    ds_read2st64_b32 v[200:201], v115 offset0:12 offset1:13
    ds_read2st64_b32 v[202:203], v116 offset0:12 offset1:13
    ds_read_b128 v[40:43], v2 offset:18432
    ds_read_b128 v[44:47], v2 offset:51200
    v_mfma_f32_4x4x4_16b_bf16 v[100:103], v[194:195], v[194:195], v[100:103]
    v_mfma_f32_4x4x4_16b_bf16 v[104:107], v[122:123], v[194:195], v[104:107]
    s_waitcnt lgkmcnt(4)
    v_mfma_f32_32x32x16_bf16 v[8:23], v[56:59], v[196:199], v[8:23]
    s_add_u32 m0, s14, 65536
    s_add_u32 s4, s12, 65536
    buffer_load_dwordx4 v118, s[40:43], s4 offen offset:0 sc1 lds
    v_mfma_f32_4x4x4_16b_bf16 v[100:103], v[196:197], v[196:197], v[100:103]
    v_mfma_f32_4x4x4_16b_bf16 v[104:107], v[122:123], v[196:197], v[104:107]
    v_mfma_f32_32x32x16_bf16 v[24:39], v[60:63], v[196:199], v[24:39]
    s_waitcnt vmcnt(13)
    ds_read2st64_b32 v[204:205], v115 offset0:16 offset1:17
    ds_read2st64_b32 v[206:207], v116 offset0:16 offset1:17
    ds_read_b128 v[48:51], v2 offset:19456
    ds_read_b128 v[52:55], v2 offset:52224
    v_mfma_f32_4x4x4_16b_bf16 v[100:103], v[198:199], v[198:199], v[100:103]
    v_mfma_f32_4x4x4_16b_bf16 v[104:107], v[122:123], v[198:199], v[104:107]
    s_waitcnt lgkmcnt(4)
    v_mfma_f32_32x32x16_bf16 v[8:23], v[40:43], v[200:203], v[8:23]
    buffer_load_dwordx4 v118, s[40:43], s4 offen offset:1024 sc1 lds
    v_mfma_f32_4x4x4_16b_bf16 v[100:103], v[200:201], v[200:201], v[100:103]
    v_mfma_f32_4x4x4_16b_bf16 v[104:107], v[122:123], v[200:201], v[104:107]
    v_mfma_f32_32x32x16_bf16 v[24:39], v[44:47], v[200:203], v[24:39]
    s_waitcnt vmcnt(13)
    ds_read2st64_b32 v[208:209], v115 offset0:20 offset1:21
    ds_read2st64_b32 v[210:211], v116 offset0:20 offset1:21
    ds_read_b128 v[56:59], v2 offset:20480
    ds_read_b128 v[60:63], v2 offset:53248
    v_mfma_f32_4x4x4_16b_bf16 v[100:103], v[202:203], v[202:203], v[100:103]
    v_mfma_f32_4x4x4_16b_bf16 v[104:107], v[122:123], v[202:203], v[104:107]
    s_waitcnt lgkmcnt(4)
    v_mfma_f32_32x32x16_bf16 v[8:23], v[48:51], v[204:207], v[8:23]
    buffer_load_dwordx4 v118, s[40:43], s4 offen offset:2048 sc1 lds
    v_mfma_f32_4x4x4_16b_bf16 v[100:103], v[204:205], v[204:205], v[100:103]
    v_mfma_f32_4x4x4_16b_bf16 v[104:107], v[122:123], v[204:205], v[104:107]
    v_mfma_f32_32x32x16_bf16 v[24:39], v[52:55], v[204:207], v[24:39]
    s_waitcnt vmcnt(13)
    ds_read2st64_b32 v[212:213], v115 offset0:24 offset1:25
    ds_read2st64_b32 v[214:215], v116 offset0:24 offset1:25
    ds_read_b128 v[40:43], v2 offset:21504
    ds_read_b128 v[44:47], v2 offset:54272
    v_mfma_f32_4x4x4_16b_bf16 v[100:103], v[206:207], v[206:207], v[100:103]
    v_mfma_f32_4x4x4_16b_bf16 v[104:107], v[122:123], v[206:207], v[104:107]
    s_waitcnt lgkmcnt(4)
    v_mfma_f32_32x32x16_bf16 v[8:23], v[56:59], v[208:211], v[8:23]
    buffer_load_dwordx4 v118, s[40:43], s4 offen offset:3072 sc1 lds
    v_mfma_f32_4x4x4_16b_bf16 v[100:103], v[208:209], v[208:209], v[100:103]
    v_mfma_f32_4x4x4_16b_bf16 v[104:107], v[122:123], v[208:209], v[104:107]
    v_mfma_f32_32x32x16_bf16 v[24:39], v[60:63], v[208:211], v[24:39]
    s_waitcnt vmcnt(13)
    ds_read2st64_b32 v[216:217], v115 offset0:28 offset1:29
    ds_read2st64_b32 v[218:219], v116 offset0:28 offset1:29
    ds_read_b128 v[48:51], v2 offset:22528
    ds_read_b128 v[52:55], v2 offset:55296
    v_mfma_f32_4x4x4_16b_bf16 v[100:103], v[210:211], v[210:211], v[100:103]
    v_mfma_f32_4x4x4_16b_bf16 v[104:107], v[122:123], v[210:211], v[104:107]
    s_waitcnt lgkmcnt(4)
    v_mfma_f32_32x32x16_bf16 v[8:23], v[40:43], v[212:215], v[8:23]
    s_add_u32 m0, s14, 69632
    s_add_u32 s4, s12, 69632
    buffer_load_dwordx4 v118, s[40:43], s4 offen offset:0 sc1 lds
    v_mfma_f32_4x4x4_16b_bf16 v[100:103], v[212:213], v[212:213], v[100:103]
    v_mfma_f32_4x4x4_16b_bf16 v[104:107], v[122:123], v[212:213], v[104:107]
    v_mfma_f32_32x32x16_bf16 v[24:39], v[44:47], v[212:215], v[24:39]
    s_waitcnt vmcnt(13)
    ds_read2st64_b32 v[220:221], v115 offset0:32 offset1:33
    ds_read2st64_b32 v[222:223], v116 offset0:32 offset1:33
    ds_read_b128 v[56:59], v2 offset:23552
    ds_read_b128 v[60:63], v2 offset:56320
    v_mfma_f32_4x4x4_16b_bf16 v[100:103], v[214:215], v[214:215], v[100:103]
    v_mfma_f32_4x4x4_16b_bf16 v[104:107], v[122:123], v[214:215], v[104:107]
    s_waitcnt lgkmcnt(4)
    v_mfma_f32_32x32x16_bf16 v[8:23], v[48:51], v[216:219], v[8:23]
    buffer_load_dwordx4 v118, s[40:43], s4 offen offset:1024 sc1 lds
    v_mfma_f32_4x4x4_16b_bf16 v[100:103], v[216:217], v[216:217], v[100:103]
    v_mfma_f32_4x4x4_16b_bf16 v[104:107], v[122:123], v[216:217], v[104:107]
    v_mfma_f32_32x32x16_bf16 v[24:39], v[52:55], v[216:219], v[24:39]
    s_waitcnt vmcnt(13)
    ds_read2st64_b32 v[224:225], v115 offset0:36 offset1:37
    ds_read2st64_b32 v[226:227], v116 offset0:36 offset1:37
    ds_read_b128 v[40:43], v2 offset:24576
    ds_read_b128 v[44:47], v2 offset:57344
    v_mfma_f32_4x4x4_16b_bf16 v[100:103], v[218:219], v[218:219], v[100:103]
    v_mfma_f32_4x4x4_16b_bf16 v[104:107], v[122:123], v[218:219], v[104:107]
    s_waitcnt lgkmcnt(4)
    v_mfma_f32_32x32x16_bf16 v[8:23], v[56:59], v[220:223], v[8:23]
    buffer_load_dwordx4 v118, s[40:43], s4 offen offset:2048 sc1 lds
    v_mfma_f32_4x4x4_16b_bf16 v[100:103], v[220:221], v[220:221], v[100:103]
    v_mfma_f32_4x4x4_16b_bf16 v[104:107], v[122:123], v[220:221], v[104:107]
    v_mfma_f32_32x32x16_bf16 v[24:39], v[60:63], v[220:223], v[24:39]
    s_waitcnt vmcnt(13)
    ds_read2st64_b32 v[228:229], v115 offset0:40 offset1:41
    ds_read2st64_b32 v[230:231], v116 offset0:40 offset1:41
    ds_read_b128 v[48:51], v2 offset:25600
    ds_read_b128 v[52:55], v2 offset:58368
    v_mfma_f32_4x4x4_16b_bf16 v[100:103], v[222:223], v[222:223], v[100:103]
    v_mfma_f32_4x4x4_16b_bf16 v[104:107], v[122:123], v[222:223], v[104:107]
    s_waitcnt lgkmcnt(4)
    v_mfma_f32_32x32x16_bf16 v[8:23], v[40:43], v[224:227], v[8:23]
    buffer_load_dwordx4 v118, s[40:43], s4 offen offset:3072 sc1 lds
    v_mfma_f32_4x4x4_16b_bf16 v[100:103], v[224:225], v[224:225], v[100:103]
    v_mfma_f32_4x4x4_16b_bf16 v[104:107], v[122:123], v[224:225], v[104:107]
    v_mfma_f32_32x32x16_bf16 v[24:39], v[44:47], v[224:227], v[24:39]
    s_waitcnt vmcnt(13)
    ds_read2st64_b32 v[232:233], v115 offset0:44 offset1:45
    ds_read2st64_b32 v[234:235], v116 offset0:44 offset1:45
    ds_read_b128 v[56:59], v2 offset:26624
    ds_read_b128 v[60:63], v2 offset:59392
    v_mfma_f32_4x4x4_16b_bf16 v[100:103], v[226:227], v[226:227], v[100:103]
    v_mfma_f32_4x4x4_16b_bf16 v[104:107], v[122:123], v[226:227], v[104:107]
    s_waitcnt lgkmcnt(4)
    v_mfma_f32_32x32x16_bf16 v[8:23], v[48:51], v[228:231], v[8:23]
    s_add_u32 m0, s11, 2048
    s_add_u32 s4, s12, 98304
    buffer_load_dwordx4 v118, s[40:43], s4 offen offset:0 sc1 lds
    v_mfma_f32_4x4x4_16b_bf16 v[100:103], v[228:229], v[228:229], v[100:103]
    v_mfma_f32_4x4x4_16b_bf16 v[104:107], v[122:123], v[228:229], v[104:107]
    v_mfma_f32_32x32x16_bf16 v[24:39], v[52:55], v[228:231], v[24:39]
    s_waitcnt vmcnt(13)
    ds_read2st64_b32 v[236:237], v115 offset0:48 offset1:49
    ds_read2st64_b32 v[238:239], v116 offset0:48 offset1:49
    ds_read_b128 v[40:43], v2 offset:27648
    ds_read_b128 v[44:47], v2 offset:60416
    v_mfma_f32_4x4x4_16b_bf16 v[100:103], v[230:231], v[230:231], v[100:103]
    v_mfma_f32_4x4x4_16b_bf16 v[104:107], v[122:123], v[230:231], v[104:107]
    s_waitcnt lgkmcnt(4)
    v_mfma_f32_32x32x16_bf16 v[8:23], v[56:59], v[232:235], v[8:23]
    buffer_load_dwordx4 v118, s[40:43], s4 offen offset:1024 sc1 lds
    v_mfma_f32_4x4x4_16b_bf16 v[100:103], v[232:233], v[232:233], v[100:103]
    v_mfma_f32_4x4x4_16b_bf16 v[104:107], v[122:123], v[232:233], v[104:107]
    v_mfma_f32_32x32x16_bf16 v[24:39], v[60:63], v[232:235], v[24:39]
    s_waitcnt vmcnt(13)
    ds_read2st64_b32 v[240:241], v115 offset0:52 offset1:53
    ds_read2st64_b32 v[242:243], v116 offset0:52 offset1:53
    ds_read_b128 v[48:51], v2 offset:28672
    ds_read_b128 v[52:55], v2 offset:61440
    v_mfma_f32_4x4x4_16b_bf16 v[100:103], v[234:235], v[234:235], v[100:103]
    v_mfma_f32_4x4x4_16b_bf16 v[104:107], v[122:123], v[234:235], v[104:107]
    s_waitcnt lgkmcnt(4)
    v_mfma_f32_32x32x16_bf16 v[8:23], v[40:43], v[236:239], v[8:23]
    buffer_load_dwordx4 v118, s[40:43], s4 offen offset:2048 sc1 lds
    v_mfma_f32_4x4x4_16b_bf16 v[100:103], v[236:237], v[236:237], v[100:103]
    v_mfma_f32_4x4x4_16b_bf16 v[104:107], v[122:123], v[236:237], v[104:107]
    v_mfma_f32_32x32x16_bf16 v[24:39], v[44:47], v[236:239], v[24:39]
    s_waitcnt vmcnt(13)
    ds_read2st64_b32 v[244:245], v115 offset0:56 offset1:57
    ds_read2st64_b32 v[246:247], v116 offset0:56 offset1:57
    ds_read_b128 v[56:59], v2 offset:29696
    ds_read_b128 v[60:63], v2 offset:62464
    v_mfma_f32_4x4x4_16b_bf16 v[100:103], v[238:239], v[238:239], v[100:103]
    v_mfma_f32_4x4x4_16b_bf16 v[104:107], v[122:123], v[238:239], v[104:107]
    s_waitcnt lgkmcnt(4)
    v_mfma_f32_32x32x16_bf16 v[8:23], v[48:51], v[240:243], v[8:23]
    buffer_load_dwordx4 v118, s[40:43], s4 offen offset:3072 sc1 lds
    v_mfma_f32_4x4x4_16b_bf16 v[100:103], v[240:241], v[240:241], v[100:103]
    v_mfma_f32_4x4x4_16b_bf16 v[104:107], v[122:123], v[240:241], v[104:107]
    v_mfma_f32_32x32x16_bf16 v[24:39], v[52:55], v[240:243], v[24:39]
    s_waitcnt vmcnt(13)
    ds_read2st64_b32 v[248:249], v115 offset0:0 offset1:1
    ds_read2st64_b32 v[250:251], v116 offset0:0 offset1:1
    ds_read_b128 v[40:43], v2 offset:30720
    ds_read_b128 v[44:47], v2 offset:63488
    v_mfma_f32_4x4x4_16b_bf16 v[100:103], v[242:243], v[242:243], v[100:103]
    v_mfma_f32_4x4x4_16b_bf16 v[104:107], v[122:123], v[242:243], v[104:107]
    s_waitcnt lgkmcnt(4)
    v_mfma_f32_32x32x16_bf16 v[8:23], v[56:59], v[244:247], v[8:23]
    s_add_u32 m0, s11, 6144
    s_add_u32 s4, s12, 102400
    buffer_load_dwordx4 v118, s[40:43], s4 offen offset:0 sc1 lds
    v_mfma_f32_4x4x4_16b_bf16 v[100:103], v[244:245], v[244:245], v[100:103]
    v_mfma_f32_4x4x4_16b_bf16 v[104:107], v[122:123], v[244:245], v[104:107]
    v_mfma_f32_32x32x16_bf16 v[24:39], v[60:63], v[244:247], v[24:39]
    s_waitcnt vmcnt(13)
    ds_read2st64_b32 v[252:253], v115 offset0:4 offset1:5
    ds_read2st64_b32 v[254:255], v116 offset0:4 offset1:5
    ds_read_b128 v[48:51], v2 offset:31744
    ds_read_b128 v[52:55], v2 offset:64512
    v_mfma_f32_4x4x4_16b_bf16 v[100:103], v[246:247], v[246:247], v[100:103]
    v_mfma_f32_4x4x4_16b_bf16 v[104:107], v[122:123], v[246:247], v[104:107]
    s_waitcnt lgkmcnt(4)
    v_mfma_f32_32x32x16_bf16 v[8:23], v[40:43], v[248:251], v[8:23]
    buffer_load_dwordx4 v118, s[40:43], s4 offen offset:1024 sc1 lds
    v_mfma_f32_4x4x4_16b_bf16 v[100:103], v[248:249], v[248:249], v[100:103]
    v_mfma_f32_4x4x4_16b_bf16 v[104:107], v[122:123], v[248:249], v[104:107]
    v_mfma_f32_32x32x16_bf16 v[24:39], v[44:47], v[248:251], v[24:39]
    s_waitcnt vmcnt(6)
    s_barrier
    ds_read_b128 v[56:59], v114 offset:0
    ds_read_b128 v[60:63], v114 offset:1024
    v_mfma_f32_4x4x4_16b_bf16 v[100:103], v[250:251], v[250:251], v[100:103]
    v_mfma_f32_4x4x4_16b_bf16 v[104:107], v[122:123], v[250:251], v[104:107]
    s_waitcnt lgkmcnt(2)
    v_mfma_f32_32x32x16_bf16 v[8:23], v[48:51], v[252:255], v[8:23]
    buffer_load_dwordx4 v118, s[40:43], s4 offen offset:2048 sc1 lds
    v_mfma_f32_4x4x4_16b_bf16 v[100:103], v[252:253], v[252:253], v[100:103]
    v_mfma_f32_4x4x4_16b_bf16 v[104:107], v[122:123], v[252:253], v[104:107]
    v_mfma_f32_32x32x16_bf16 v[24:39], v[52:55], v[252:255], v[24:39]
    ds_read_b128 v[40:43], v114 offset:2048
    ds_read_b128 v[44:47], v114 offset:3072
    v_mfma_f32_4x4x4_16b_bf16 v[100:103], v[254:255], v[254:255], v[100:103]
    v_mfma_f32_4x4x4_16b_bf16 v[104:107], v[122:123], v[254:255], v[104:107]
    s_waitcnt lgkmcnt(2)
    v_mfma_f32_32x32x16_bf16 v[84:99], v[56:59], v[128:131], 0
    ds_read_b128 v[48:51], v114 offset:4096
    buffer_load_dwordx4 v118, s[40:43], s4 offen offset:3072 sc1 lds
    ds_read_b128 v[64:67], v119 offset:0
    ds_read_b128 v[68:71], v119 offset:16
    v_mfma_f32_32x32x16_bf16 v[84:99], v[60:63], v[132:135], v[84:99]
    ds_read_b128 v[52:55], v114 offset:5120
    ds_read_b128 v[72:75], v119 offset:32
    ds_read_b128 v[76:79], v119 offset:48
    s_mov_b32 vcc_lo, 0x22222222
    s_mov_b32 vcc_hi, 0x22222222
    v_cndmask_b32 v110, v100, v101, vcc
    s_waitcnt lgkmcnt(6)
    v_mfma_f32_32x32x16_bf16 v[84:99], v[40:43], v[136:139], v[84:99]
    ds_read_b128 v[56:59], v114 offset:6144
    s_lshl_b64 vcc, vcc, 1
    v_cndmask_b32 v110, v110, v102, vcc
    s_lshl_b64 vcc, vcc, 1
    v_cndmask_b32 v110, v110, v103, vcc
    v_mfma_f32_32x32x16_bf16 v[84:99], v[44:47], v[140:143], v[84:99]
    ds_read_b128 v[60:63], v114 offset:7168
    v_mov_b32 v108, v104
    s_mov_b32 s5, 0x3b000000
    s_nop 0
    v_permlane32_swap_b32 v108, v110
    v_add_f32 v108, v108, v110
    v_mov_b32 v110, v108
    s_waitcnt lgkmcnt(4)
    v_mfma_f32_32x32x16_bf16 v[84:99], v[48:51], v[144:147], v[84:99]
    ds_read_b128 v[40:43], v114 offset:8192
    v_permlane32_swap_b32 v108, v110
    v_mul_f32 v108, s5, v108
    v_mul_f32 v108, v108, v108
    v_fma_f32 v108, v110, s5, -v108
    v_mfma_f32_32x32x16_bf16 v[84:99], v[52:55], v[148:151], v[84:99]
    ds_read_b128 v[44:47], v114 offset:9216
    v_add_f32 v108, 0x3727c5ac, v108
    v_rsq_f32 v108, v108
    s_nop 0
    v_mul_f32 v112, 0xbfb8aa3b, v108
    v_mul_f32 v113, 0xbf317218, v108
    s_waitcnt lgkmcnt(4)
    s_waitcnt lgkmcnt(2)
    v_mfma_f32_32x32x16_bf16 v[84:99], v[56:59], v[152:155], v[84:99]
    ds_read_b128 v[48:51], v114 offset:10240
    ds_read_b128 v[100:103], v119 offset:128
    ds_read_b128 v[104:107], v119 offset:144
    ds_read_b128 v[108:111], v119 offset:160
    ds_read_b128 v[124:127], v119 offset:176
    v_mfma_f32_32x32x16_bf16 v[84:99], v[60:63], v[156:159], v[84:99]
    ds_read_b128 v[52:55], v114 offset:11264
    v_fma_f32 v8, v112, v8, v64
    v_fma_f32 v12, v112, v12, v68
    v_exp_f32 v64, v8
    v_fma_f32 v16, v113, v16, v72
    s_waitcnt lgkmcnt(6)
    v_mfma_f32_32x32x16_bf16 v[84:99], v[40:43], v[160:163], v[84:99]
    ds_read_b128 v[56:59], v114 offset:12288
    v_exp_f32 v68, v12
    v_fma_f32 v20, v113, v20, v76
    v_add_f32 v64, 1.0, v64
    v_mfma_f32_32x32x16_bf16 v[84:99], v[44:47], v[164:167], v[84:99]
    ds_read_b128 v[60:63], v114 offset:13312
    v_mul_f32 v16, v8, v16
    v_rcp_f32 v64, v64
    v_add_f32 v68, 1.0, v68
    s_waitcnt lgkmcnt(2)
    v_mfma_f32_32x32x16_bf16 v[84:99], v[48:51], v[168:171], v[84:99]
    ds_read_b128 v[40:43], v114 offset:14336
    v_rcp_f32 v68, v68
    v_mul_f32 v20, v12, v20
    v_mul_f32 v16, v16, v64
    v_mfma_f32_32x32x16_bf16 v[84:99], v[52:55], v[172:175], v[84:99]
    ds_read_b128 v[44:47], v114 offset:15360
    v_mul_f32 v20, v20, v68
    v_cvt_pk_bf16_f32 v80, v16, v20
    v_fma_f32 v9, v112, v9, v65
    v_fma_f32 v13, v112, v13, v69
    s_waitcnt lgkmcnt(2)
    v_mfma_f32_32x32x16_bf16 v[84:99], v[56:59], v[176:179], v[84:99]
    ds_read_b128 v[48:51], v114 offset:16384
    v_exp_f32 v65, v9
    v_fma_f32 v17, v113, v17, v73
    v_mfma_f32_32x32x16_bf16 v[84:99], v[60:63], v[180:183], v[84:99]
    ds_read_b128 v[52:55], v114 offset:17408
    v_exp_f32 v69, v13
    v_fma_f32 v21, v113, v21, v77
    v_add_f32 v65, 1.0, v65
    v_mul_f32 v17, v9, v17
    s_waitcnt lgkmcnt(2)
    v_mfma_f32_32x32x16_bf16 v[84:99], v[40:43], v[184:187], v[84:99]
    ds_read_b128 v[56:59], v114 offset:18432
    s_waitcnt vmcnt(0)
    s_barrier
    v_rcp_f32 v65, v65
    v_mfma_f32_32x32x16_bf16 v[84:99], v[44:47], v[188:191], v[84:99]
    ds_read_b128 v[60:63], v114 offset:19456
    s_add_u32 m0, s14, 0
    s_add_u32 s4, s12, 131072
    buffer_load_dwordx4 v118, s[40:43], s4 offen offset:0 sc1 lds
    v_add_f32 v69, 1.0, v69
    s_waitcnt lgkmcnt(2)
    v_mfma_f32_32x32x16_bf16 v[84:99], v[48:51], v[192:195], v[84:99]
    ds_read_b128 v[40:43], v114 offset:20480
    v_rcp_f32 v69, v69
    v_mul_f32 v21, v13, v21
    v_mul_f32 v17, v17, v65
    v_mfma_f32_32x32x16_bf16 v[84:99], v[52:55], v[196:199], v[84:99]
    ds_read_b128 v[44:47], v114 offset:21504
    buffer_load_dwordx4 v118, s[40:43], s4 offen offset:1024 sc1 lds
    v_mul_f32 v21, v21, v69
    v_cvt_pk_bf16_f32 v81, v17, v21
    v_fma_f32 v10, v112, v10, v66
    s_waitcnt lgkmcnt(2)
    v_mfma_f32_32x32x16_bf16 v[84:99], v[56:59], v[200:203], v[84:99]
    ds_read_b128 v[48:51], v114 offset:22528
    v_fma_f32 v14, v112, v14, v70
    v_exp_f32 v66, v10
    v_fma_f32 v18, v113, v18, v74
    v_mfma_f32_32x32x16_bf16 v[84:99], v[60:63], v[204:207], v[84:99]
    ds_read_b128 v[52:55], v114 offset:23552
    buffer_load_dwordx4 v118, s[40:43], s4 offen offset:2048 sc1 lds
    v_exp_f32 v70, v14
    v_fma_f32 v22, v113, v22, v78
    s_waitcnt lgkmcnt(2)
    v_mfma_f32_32x32x16_bf16 v[84:99], v[40:43], v[208:211], v[84:99]
    ds_read_b128 v[56:59], v114 offset:24576
    v_add_f32 v66, 1.0, v66
    v_mul_f32 v18, v10, v18
    v_rcp_f32 v66, v66
    v_mfma_f32_32x32x16_bf16 v[84:99], v[44:47], v[212:215], v[84:99]
    ds_read_b128 v[60:63], v114 offset:25600
    buffer_load_dwordx4 v118, s[40:43], s4 offen offset:3072 sc1 lds
    v_add_f32 v70, 1.0, v70
    v_rcp_f32 v70, v70
    s_waitcnt lgkmcnt(2)
    v_mfma_f32_32x32x16_bf16 v[84:99], v[48:51], v[216:219], v[84:99]
    ds_read_b128 v[40:43], v114 offset:26624
    v_mul_f32 v22, v14, v22
    v_mul_f32 v18, v18, v66
    v_mul_f32 v22, v22, v70
    v_cvt_pk_bf16_f32 v82, v18, v22
    v_mfma_f32_32x32x16_bf16 v[84:99], v[52:55], v[220:223], v[84:99]
    ds_read_b128 v[44:47], v114 offset:27648
    s_add_u32 m0, s14, 4096
    s_add_u32 s4, s12, 135168
    buffer_load_dwordx4 v118, s[40:43], s4 offen offset:0 sc1 lds
    v_fma_f32 v11, v112, v11, v67
    s_waitcnt lgkmcnt(2)
    v_mfma_f32_32x32x16_bf16 v[84:99], v[56:59], v[224:227], v[84:99]
    ds_read_b128 v[48:51], v114 offset:28672
    v_fma_f32 v15, v112, v15, v71
    v_exp_f32 v67, v11
    v_fma_f32 v19, v113, v19, v75
    v_mfma_f32_32x32x16_bf16 v[84:99], v[60:63], v[228:231], v[84:99]
    ds_read_b128 v[52:55], v114 offset:29696
    buffer_load_dwordx4 v118, s[40:43], s4 offen offset:1024 sc1 lds
    v_exp_f32 v71, v15
    v_fma_f32 v23, v113, v23, v79
    s_waitcnt lgkmcnt(2)
    v_mfma_f32_32x32x16_bf16 v[84:99], v[40:43], v[232:235], v[84:99]
    ds_read_b128 v[56:59], v114 offset:30720
    v_add_f32 v67, 1.0, v67
    v_mul_f32 v19, v11, v19
    v_rcp_f32 v67, v67
    v_mfma_f32_32x32x16_bf16 v[84:99], v[44:47], v[236:239], v[84:99]
    ds_read_b128 v[60:63], v114 offset:31744
    buffer_load_dwordx4 v118, s[40:43], s4 offen offset:2048 sc1 lds
    v_add_f32 v71, 1.0, v71
    v_rcp_f32 v71, v71
    s_waitcnt lgkmcnt(2)
    v_mfma_f32_32x32x16_bf16 v[84:99], v[48:51], v[240:243], v[84:99]
    ds_read_b128 v[40:43], v120 offset:2048
    v_mul_f32 v23, v15, v23
    v_mul_f32 v19, v19, v67
    v_mul_f32 v23, v23, v71
    v_cvt_pk_bf16_f32 v83, v19, v23
    v_mfma_f32_32x32x16_bf16 v[84:99], v[52:55], v[244:247], v[84:99]
    ds_read_b128 v[44:47], v120 offset:3072
    buffer_load_dwordx4 v118, s[40:43], s4 offen offset:3072 sc1 lds
    buffer_store_dwordx4 v[80:83], v2, s[40:43], s13 offen offset:0 sc1
    ds_read_b128 v[64:67], v119 offset:256
    s_waitcnt lgkmcnt(3)
    v_mfma_f32_32x32x16_bf16 v[84:99], v[56:59], v[248:251], v[84:99]
    ds_read_b128 v[48:51], v120 offset:4096
    ds_read_b128 v[68:71], v119 offset:272
    ds_read_b128 v[72:75], v119 offset:288
    ds_read_b128 v[76:79], v119 offset:304
    v_fma_f32 v24, v112, v24, v100
    v_mfma_f32_32x32x16_bf16 v[84:99], v[60:63], v[252:255], v[84:99]
    ds_read_b128 v[52:55], v120 offset:5120
    s_add_u32 m0, s14, 32768
    s_add_u32 s4, s12, 163840
    buffer_load_dwordx4 v118, s[40:43], s4 offen offset:0 sc1 lds
    v_fma_f32 v28, v112, v28, v104
    s_waitcnt lgkmcnt(6)
    v_mfma_f32_32x32x16_bf16 v[8:23], v[40:43], v[128:131], 0
    ds_read_b128 v[56:59], v120 offset:6144
    v_exp_f32 v100, v24
    v_fma_f32 v32, v113, v32, v108
    v_mfma_f32_32x32x16_bf16 v[8:23], v[44:47], v[132:135], v[8:23]
    ds_read_b128 v[60:63], v120 offset:7168
    buffer_load_dwordx4 v118, s[40:43], s4 offen offset:1024 sc1 lds
    v_exp_f32 v104, v28
    v_fma_f32 v36, v113, v36, v124
    s_waitcnt lgkmcnt(2)
    v_mfma_f32_32x32x16_bf16 v[8:23], v[48:51], v[136:139], v[8:23]
    ds_read_b128 v[40:43], v120 offset:8192
    v_add_f32 v100, 1.0, v100
    v_mul_f32 v32, v24, v32
    v_rcp_f32 v100, v100
    v_mfma_f32_32x32x16_bf16 v[8:23], v[52:55], v[140:143], v[8:23]
    ds_read_b128 v[44:47], v120 offset:9216
    buffer_load_dwordx4 v118, s[40:43], s4 offen offset:2048 sc1 lds
    v_add_f32 v104, 1.0, v104
    v_rcp_f32 v104, v104
    s_waitcnt lgkmcnt(2)
    v_mfma_f32_32x32x16_bf16 v[8:23], v[56:59], v[144:147], v[8:23]
    ds_read_b128 v[48:51], v120 offset:17408
    v_mul_f32 v36, v28, v36
    v_mul_f32 v32, v32, v100
    v_mul_f32 v36, v36, v104
    v_cvt_pk_bf16_f32 v80, v32, v36
    v_mfma_f32_32x32x16_bf16 v[8:23], v[60:63], v[148:151], v[8:23]
    ds_read_b128 v[52:55], v120 offset:18432
    buffer_load_dwordx4 v118, s[40:43], s4 offen offset:3072 sc1 lds
    v_fma_f32 v25, v112, v25, v101
    v_fma_f32 v29, v112, v29, v105
    s_waitcnt lgkmcnt(2)
    v_mfma_f32_32x32x16_bf16 v[8:23], v[40:43], v[152:155], v[8:23]
    ds_read_b128 v[56:59], v120 offset:19456
    v_exp_f32 v101, v25
    v_fma_f32 v33, v113, v33, v109
    v_mfma_f32_32x32x16_bf16 v[8:23], v[44:47], v[156:159], v[8:23]
    ds_read_b128 v[60:63], v120 offset:20480
    s_add_u32 m0, s14, 36864
    s_add_u32 s4, s12, 167936
    buffer_load_dwordx4 v118, s[40:43], s4 offen offset:0 sc1 lds
    s_waitcnt lgkmcnt(2)
    v_mfma_f32_32x32x16_bf16 v[8:23], v[48:51], v[160:163], v[8:23]
    ds_read_b128 v[40:43], v120 offset:21504
    v_exp_f32 v105, v29
    v_fma_f32 v37, v113, v37, v125
    v_add_f32 v101, 1.0, v101
    v_mfma_f32_32x32x16_bf16 v[8:23], v[52:55], v[164:167], v[8:23]
    ds_read_b128 v[44:47], v120 offset:22528
    buffer_load_dwordx4 v118, s[40:43], s4 offen offset:1024 sc1 lds
    v_mul_f32 v33, v25, v33
    v_rcp_f32 v101, v101
    s_waitcnt lgkmcnt(2)
    v_mfma_f32_32x32x16_bf16 v[8:23], v[56:59], v[168:171], v[8:23]
    ds_read_b128 v[48:51], v120 offset:23552
    v_add_f32 v105, 1.0, v105
    v_rcp_f32 v105, v105
    v_mul_f32 v37, v29, v37
    v_mfma_f32_32x32x16_bf16 v[8:23], v[60:63], v[172:175], v[8:23]
    ds_read_b128 v[52:55], v120 offset:24576
    buffer_load_dwordx4 v118, s[40:43], s4 offen offset:2048 sc1 lds
    v_mul_f32 v33, v33, v101
    v_mul_f32 v37, v37, v105
    v_cvt_pk_bf16_f32 v81, v33, v37
    s_waitcnt lgkmcnt(2)
    v_mfma_f32_32x32x16_bf16 v[8:23], v[40:43], v[176:179], v[8:23]
    ds_read_b128 v[56:59], v120 offset:32768
    v_fma_f32 v26, v112, v26, v102
    v_fma_f32 v30, v112, v30, v106
    v_exp_f32 v102, v26
    v_mfma_f32_32x32x16_bf16 v[8:23], v[44:47], v[180:183], v[8:23]
    ds_read_b128 v[60:63], v120 offset:33792
    buffer_load_dwordx4 v118, s[40:43], s4 offen offset:3072 sc1 lds
    v_fma_f32 v34, v113, v34, v110
    v_exp_f32 v106, v30
    s_waitcnt lgkmcnt(2)
    v_mfma_f32_32x32x16_bf16 v[8:23], v[48:51], v[184:187], v[8:23]
    ds_read_b128 v[40:43], v120 offset:34816
    s_waitcnt vmcnt(9)
    s_barrier
    v_fma_f32 v38, v113, v38, v126
    v_add_f32 v102, 1.0, v102
    v_mfma_f32_32x32x16_bf16 v[8:23], v[52:55], v[188:191], v[8:23]
    ds_read_b128 v[44:47], v120 offset:35840
    s_add_u32 m0, s14, 65536
    s_add_u32 s4, s12, 196608
    buffer_load_dwordx4 v118, s[40:43], s4 offen offset:0 sc1 lds
    v_mul_f32 v34, v26, v34
    s_waitcnt lgkmcnt(2)
    v_mfma_f32_32x32x16_bf16 v[8:23], v[56:59], v[192:195], v[8:23]
    ds_read_b128 v[48:51], v120 offset:36864
    v_rcp_f32 v102, v102
    v_add_f32 v106, 1.0, v106
    v_mfma_f32_32x32x16_bf16 v[8:23], v[60:63], v[196:199], v[8:23]
    ds_read_b128 v[52:55], v120 offset:37888
    buffer_load_dwordx4 v118, s[40:43], s4 offen offset:1024 sc1 lds
    v_rcp_f32 v106, v106
    v_mul_f32 v38, v30, v38
    s_waitcnt lgkmcnt(2)
    v_mfma_f32_32x32x16_bf16 v[8:23], v[40:43], v[200:203], v[8:23]
    ds_read_b128 v[56:59], v120 offset:38912
    v_mul_f32 v34, v34, v102
    v_mul_f32 v38, v38, v106
    v_cvt_pk_bf16_f32 v82, v34, v38
    v_fma_f32 v27, v112, v27, v103
    v_mfma_f32_32x32x16_bf16 v[8:23], v[44:47], v[204:207], v[8:23]
    ds_read_b128 v[60:63], v120 offset:39936
    buffer_load_dwordx4 v118, s[40:43], s4 offen offset:2048 sc1 lds
    v_fma_f32 v31, v112, v31, v107
    v_exp_f32 v103, v27
    s_waitcnt lgkmcnt(2)
    v_mfma_f32_32x32x16_bf16 v[8:23], v[48:51], v[208:211], v[8:23]
    ds_read_b128 v[40:43], v120 offset:48128
    v_fma_f32 v35, v113, v35, v111
    v_exp_f32 v107, v31
    v_fma_f32 v39, v113, v39, v127
    v_mfma_f32_32x32x16_bf16 v[8:23], v[52:55], v[212:215], v[8:23]
    ds_read_b128 v[44:47], v120 offset:49152
    buffer_load_dwordx4 v118, s[40:43], s4 offen offset:3072 sc1 lds
    v_add_f32 v103, 1.0, v103
    v_mul_f32 v35, v27, v35
    s_waitcnt lgkmcnt(2)
    v_mfma_f32_32x32x16_bf16 v[8:23], v[56:59], v[216:219], v[8:23]
    ds_read_b128 v[48:51], v120 offset:50176
    v_rcp_f32 v103, v103
    v_add_f32 v107, 1.0, v107
    v_mfma_f32_32x32x16_bf16 v[8:23], v[60:63], v[220:223], v[8:23]
    ds_read_b128 v[52:55], v120 offset:51200
    s_add_u32 m0, s14, 69632
    s_add_u32 s4, s12, 200704
    buffer_load_dwordx4 v118, s[40:43], s4 offen offset:0 sc1 lds
    s_waitcnt lgkmcnt(2)
    v_mfma_f32_32x32x16_bf16 v[8:23], v[40:43], v[224:227], v[8:23]
    ds_read_b128 v[56:59], v120 offset:52224
    v_rcp_f32 v107, v107
    v_mul_f32 v39, v31, v39
    v_mul_f32 v35, v35, v103
    v_mfma_f32_32x32x16_bf16 v[8:23], v[44:47], v[228:231], v[8:23]
    ds_read_b128 v[60:63], v120 offset:53248
    buffer_load_dwordx4 v118, s[40:43], s4 offen offset:1024 sc1 lds
    v_mul_f32 v39, v39, v107
    v_cvt_pk_bf16_f32 v83, v35, v39
    s_waitcnt lgkmcnt(2)
    v_mfma_f32_32x32x16_bf16 v[8:23], v[48:51], v[232:235], v[8:23]
    ds_read_b128 v[40:43], v120 offset:54272
    buffer_store_dwordx4 v[80:83], v2, s[40:43], s13 offen offset:1024 sc1
    ds_read_b128 v[100:103], v119 offset:384
    ds_read_b128 v[104:107], v119 offset:400
    v_mfma_f32_32x32x16_bf16 v[8:23], v[52:55], v[236:239], v[8:23]
    ds_read_b128 v[44:47], v120 offset:55296
    buffer_load_dwordx4 v118, s[40:43], s4 offen offset:2048 sc1 lds
    ds_read_b128 v[108:111], v119 offset:416
    ds_read_b128 v[124:127], v119 offset:432
    v_fma_f32 v84, v112, v84, v64
    s_waitcnt lgkmcnt(6)
    v_mfma_f32_32x32x16_bf16 v[8:23], v[56:59], v[240:243], v[8:23]
    ds_read_b128 v[48:51], v2 offset:0
    v_fma_f32 v88, v112, v88, v68
    v_exp_f32 v64, v84
    v_fma_f32 v92, v113, v92, v72
    v_mfma_f32_32x32x16_bf16 v[8:23], v[60:63], v[244:247], v[8:23]
    ds_read_b128 v[52:55], v2 offset:1024
    buffer_load_dwordx4 v118, s[40:43], s4 offen offset:3072 sc1 lds
    v_exp_f32 v68, v88
    v_fma_f32 v96, v113, v96, v76
    s_waitcnt lgkmcnt(4)
    v_mfma_f32_32x32x16_bf16 v[8:23], v[40:43], v[248:251], v[8:23]
    ds_read_b128 v[56:59], v2 offset:2048
    v_add_f32 v64, 1.0, v64
    v_mul_f32 v92, v84, v92
    v_rcp_f32 v64, v64
    v_mfma_f32_32x32x16_bf16 v[8:23], v[44:47], v[252:255], v[8:23]
    ds_read_b128 v[60:63], v2 offset:3072
    v_add_f32 v68, 1.0, v68
    v_rcp_f32 v68, v68
    v_mul_f32 v96, v88, v96
    v_mul_f32 v92, v92, v64
    s_waitcnt lgkmcnt(2)
    v_mfma_f32_32x32x16_bf16 v[24:39], v[48:51], v[128:131], 0
    ds_read_b128 v[40:43], v2 offset:4096
    v_mul_f32 v96, v96, v68
    v_cvt_pk_bf16_f32 v80, v92, v96
    v_fma_f32 v85, v112, v85, v65
    v_fma_f32 v89, v112, v89, v69
    v_mfma_f32_32x32x16_bf16 v[24:39], v[52:55], v[132:135], v[24:39]
    ds_read_b128 v[44:47], v2 offset:5120
    buffer_load_dwordx4 a[128:131], v2, s[40:43], s22 offen offset:0 sc1
    v_exp_f32 v65, v85
    v_fma_f32 v93, v113, v93, v73
    s_waitcnt lgkmcnt(2)
    v_mfma_f32_32x32x16_bf16 v[24:39], v[56:59], v[136:139], v[24:39]
    ds_read_b128 v[48:51], v2 offset:6144
    v_exp_f32 v69, v89
    v_fma_f32 v97, v113, v97, v77
    v_add_f32 v65, 1.0, v65
    v_mfma_f32_32x32x16_bf16 v[24:39], v[60:63], v[140:143], v[24:39]
    ds_read_b128 v[52:55], v2 offset:7168
    v_mul_f32 v93, v85, v93
    v_rcp_f32 v65, v65
    v_add_f32 v69, 1.0, v69
    s_waitcnt lgkmcnt(2)
    v_mfma_f32_32x32x16_bf16 v[24:39], v[40:43], v[144:147], v[24:39]
    ds_read_b128 v[56:59], v2 offset:8192
    v_rcp_f32 v69, v69
    v_mul_f32 v97, v89, v97
    v_mul_f32 v93, v93, v65
    v_mfma_f32_32x32x16_bf16 v[24:39], v[44:47], v[148:151], v[24:39]
    ds_read_b128 v[60:63], v2 offset:9216
    buffer_load_dwordx4 a[132:135], v2, s[40:43], s23 offen offset:0 sc1
    v_mul_f32 v97, v97, v69
    v_cvt_pk_bf16_f32 v81, v93, v97
    v_fma_f32 v86, v112, v86, v66
    s_waitcnt lgkmcnt(2)
    v_mfma_f32_32x32x16_bf16 v[24:39], v[48:51], v[152:155], v[24:39]
    ds_read_b128 v[40:43], v2 offset:10240
    v_fma_f32 v90, v112, v90, v70
    v_exp_f32 v66, v86
    v_fma_f32 v94, v113, v94, v74
    v_mfma_f32_32x32x16_bf16 v[24:39], v[52:55], v[156:159], v[24:39]
    ds_read_b128 v[44:47], v2 offset:11264
    v_exp_f32 v70, v90
    v_fma_f32 v98, v113, v98, v78
    v_add_f32 v66, 1.0, v66
    v_mul_f32 v94, v86, v94
    s_waitcnt lgkmcnt(2)
    v_mfma_f32_32x32x16_bf16 v[24:39], v[56:59], v[160:163], v[24:39]
    ds_read_b128 v[48:51], v2 offset:12288
    v_rcp_f32 v66, v66
    v_add_f32 v70, 1.0, v70
    v_mfma_f32_32x32x16_bf16 v[24:39], v[60:63], v[164:167], v[24:39]
    ds_read_b128 v[52:55], v2 offset:13312
    buffer_load_dwordx4 a[136:139], v2, s[40:43], s22 offen offset:1024 sc1
    v_rcp_f32 v70, v70
    v_mul_f32 v98, v90, v98
    s_waitcnt lgkmcnt(2)
    v_mfma_f32_32x32x16_bf16 v[24:39], v[40:43], v[168:171], v[24:39]
    ds_read_b128 v[56:59], v2 offset:14336
    v_mul_f32 v94, v94, v66
    v_mul_f32 v98, v98, v70
    v_cvt_pk_bf16_f32 v82, v94, v98
    v_fma_f32 v87, v112, v87, v67
    v_mfma_f32_32x32x16_bf16 v[24:39], v[44:47], v[172:175], v[24:39]
    ds_read_b128 v[60:63], v2 offset:15360
    v_fma_f32 v91, v112, v91, v71
    v_exp_f32 v67, v87
    v_fma_f32 v95, v113, v95, v75
    s_waitcnt lgkmcnt(2)
    v_mfma_f32_32x32x16_bf16 v[24:39], v[48:51], v[176:179], v[24:39]
    ds_read_b128 v[40:43], v2 offset:16384
    v_exp_f32 v71, v91
    v_fma_f32 v99, v113, v99, v79
    v_add_f32 v67, 1.0, v67
    v_mfma_f32_32x32x16_bf16 v[24:39], v[52:55], v[180:183], v[24:39]
    ds_read_b128 v[44:47], v2 offset:17408
    buffer_load_dwordx4 a[140:143], v2, s[40:43], s23 offen offset:1024 sc1
    v_mul_f32 v95, v87, v95
    v_rcp_f32 v67, v67
    s_waitcnt lgkmcnt(2)
    v_mfma_f32_32x32x16_bf16 v[24:39], v[56:59], v[184:187], v[24:39]
    ds_read_b128 v[48:51], v2 offset:18432
    s_waitcnt vmcnt(4)
    s_barrier
    v_add_f32 v71, 1.0, v71
    v_mfma_f32_32x32x16_bf16 v[24:39], v[60:63], v[188:191], v[24:39]
    ds_read_b128 v[52:55], v2 offset:19456
    v_rcp_f32 v71, v71
    v_mul_f32 v99, v91, v99
    v_mul_f32 v95, v95, v67
    v_mul_f32 v99, v99, v71
    s_waitcnt lgkmcnt(2)
    v_mfma_f32_32x32x16_bf16 v[24:39], v[40:43], v[192:195], v[24:39]
    ds_read_b128 v[56:59], v2 offset:20480
    v_cvt_pk_bf16_f32 v83, v95, v99
    buffer_store_dwordx4 v[80:83], v2, s[40:43], s13 offen offset:2048 sc1
    ds_read_b128 v[64:67], v119 offset:512
    v_mfma_f32_32x32x16_bf16 v[24:39], v[44:47], v[196:199], v[24:39]
    ds_read_b128 v[60:63], v2 offset:21504
    buffer_load_dwordx4 a[144:147], v2, s[40:43], s22 offen offset:2048 sc1
    ds_read_b128 v[68:71], v119 offset:528
    ds_read_b128 v[72:75], v119 offset:544
    ds_read_b128 v[76:79], v119 offset:560
    s_waitcnt lgkmcnt(6)
    v_mfma_f32_32x32x16_bf16 v[24:39], v[48:51], v[200:203], v[24:39]
    ds_read_b128 v[40:43], v2 offset:22528
    v_fma_f32 v8, v112, v8, v100
    v_fma_f32 v12, v112, v12, v104
    v_exp_f32 v100, v8
    v_mfma_f32_32x32x16_bf16 v[24:39], v[52:55], v[204:207], v[24:39]
    ds_read_b128 v[44:47], v2 offset:23552
    v_fma_f32 v16, v113, v16, v108
    v_exp_f32 v104, v12
    v_fma_f32 v20, v113, v20, v124
    v_add_f32 v100, 1.0, v100
    s_waitcnt lgkmcnt(5)
    v_mfma_f32_32x32x16_bf16 v[24:39], v[56:59], v[208:211], v[24:39]
    ds_read_b128 v[48:51], v2 offset:24576
    v_mul_f32 v16, v8, v16
    v_rcp_f32 v100, v100
    v_add_f32 v104, 1.0, v104
    v_mfma_f32_32x32x16_bf16 v[24:39], v[60:63], v[212:215], v[24:39]
    ds_read_b128 v[52:55], v2 offset:25600
    buffer_load_dwordx4 a[148:151], v2, s[40:43], s23 offen offset:2048 sc1
    v_rcp_f32 v104, v104
    v_mul_f32 v20, v12, v20
    s_waitcnt lgkmcnt(2)
    v_mfma_f32_32x32x16_bf16 v[24:39], v[40:43], v[216:219], v[24:39]
    ds_read_b128 v[56:59], v2 offset:26624
    v_mul_f32 v16, v16, v100
    v_mul_f32 v20, v20, v104
    v_cvt_pk_bf16_f32 v80, v16, v20
    v_fma_f32 v9, v112, v9, v101
    v_mfma_f32_32x32x16_bf16 v[24:39], v[44:47], v[220:223], v[24:39]
    ds_read_b128 v[60:63], v2 offset:27648
    v_fma_f32 v13, v112, v13, v105
    v_exp_f32 v101, v9
    v_fma_f32 v17, v113, v17, v109
    s_waitcnt lgkmcnt(2)
    v_mfma_f32_32x32x16_bf16 v[24:39], v[48:51], v[224:227], v[24:39]
    ds_read_b128 v[40:43], v2 offset:28672
    v_exp_f32 v105, v13
    v_fma_f32 v21, v113, v21, v125
    v_add_f32 v101, 1.0, v101
    v_mfma_f32_32x32x16_bf16 v[24:39], v[52:55], v[228:231], v[24:39]
    ds_read_b128 v[44:47], v2 offset:29696
    buffer_load_dwordx4 a[152:155], v2, s[40:43], s22 offen offset:3072 sc1
    s_add_u32 s22, s22, 4096
    v_mul_f32 v17, v9, v17
    s_waitcnt lgkmcnt(2)
    v_mfma_f32_32x32x16_bf16 v[24:39], v[56:59], v[232:235], v[24:39]
    ds_read_b128 v[48:51], v2 offset:30720
    v_rcp_f32 v101, v101
    v_add_f32 v105, 1.0, v105
    v_mfma_f32_32x32x16_bf16 v[24:39], v[60:63], v[236:239], v[24:39]
    ds_read_b128 v[52:55], v2 offset:31744
    v_rcp_f32 v105, v105
    v_mul_f32 v21, v13, v21
    v_mul_f32 v17, v17, v101
    v_mul_f32 v21, v21, v105
    s_waitcnt lgkmcnt(2)
    v_mfma_f32_32x32x16_bf16 v[24:39], v[40:43], v[240:243], v[24:39]
    ds_read_b128 v[56:59], v2 offset:32768
    v_cvt_pk_bf16_f32 v81, v17, v21
    v_fma_f32 v10, v112, v10, v102
    v_fma_f32 v14, v112, v14, v106
    v_mfma_f32_32x32x16_bf16 v[24:39], v[44:47], v[244:247], v[24:39]
    ds_read_b128 v[60:63], v2 offset:33792
    buffer_load_dwordx4 a[156:159], v2, s[40:43], s23 offen offset:3072 sc1
    s_add_u32 s23, s23, 4096
    v_exp_f32 v102, v10
    s_waitcnt lgkmcnt(2)
    v_mfma_f32_32x32x16_bf16 v[24:39], v[48:51], v[248:251], v[24:39]
    ds_read_b128 v[40:43], v2 offset:34816
    v_fma_f32 v18, v113, v18, v110
    v_exp_f32 v106, v14
    v_fma_f32 v22, v113, v22, v126
    v_mfma_f32_32x32x16_bf16 v[24:39], v[52:55], v[252:255], v[24:39]
    ds_read_b128 v[44:47], v2 offset:35840
    v_add_f32 v102, 1.0, v102
    v_mul_f32 v18, v10, v18
    v_rcp_f32 v102, v102
    v_add_f32 v106, 1.0, v106
    s_waitcnt lgkmcnt(2)
    v_mfma_f32_32x32x16_bf16 v[84:99], v[56:59], v[128:131], 0
    ds_read_b128 v[48:51], v2 offset:36864
    v_rcp_f32 v106, v106
    v_mul_f32 v22, v14, v22
    v_mul_f32 v18, v18, v102
    v_mfma_f32_32x32x16_bf16 v[84:99], v[60:63], v[132:135], v[84:99]
    ds_read_b128 v[52:55], v2 offset:37888
    buffer_load_dwordx4 a[160:163], v2, s[40:43], s22 offen offset:0 sc1
    v_mul_f32 v22, v22, v106
    v_cvt_pk_bf16_f32 v82, v18, v22
    v_fma_f32 v11, v112, v11, v103
    s_waitcnt lgkmcnt(2)
    v_mfma_f32_32x32x16_bf16 v[84:99], v[40:43], v[136:139], v[84:99]
    ds_read_b128 v[56:59], v2 offset:38912
    v_fma_f32 v15, v112, v15, v107
    v_exp_f32 v103, v11
    v_fma_f32 v19, v113, v19, v111
    v_mfma_f32_32x32x16_bf16 v[84:99], v[44:47], v[140:143], v[84:99]
    ds_read_b128 v[60:63], v2 offset:39936
    v_exp_f32 v107, v15
    v_fma_f32 v23, v113, v23, v127
    v_add_f32 v103, 1.0, v103
    v_mul_f32 v19, v11, v19
    s_waitcnt lgkmcnt(2)
    v_mfma_f32_32x32x16_bf16 v[84:99], v[48:51], v[144:147], v[84:99]
    ds_read_b128 v[40:43], v2 offset:40960
    v_rcp_f32 v103, v103
    v_add_f32 v107, 1.0, v107
    v_mfma_f32_32x32x16_bf16 v[84:99], v[52:55], v[148:151], v[84:99]
    ds_read_b128 v[44:47], v2 offset:41984
    buffer_load_dwordx4 a[164:167], v2, s[40:43], s23 offen offset:0 sc1
    v_rcp_f32 v107, v107
    v_mul_f32 v23, v15, v23
    s_waitcnt lgkmcnt(2)
    v_mfma_f32_32x32x16_bf16 v[84:99], v[56:59], v[152:155], v[84:99]
    ds_read_b128 v[48:51], v2 offset:43008
    v_mul_f32 v19, v19, v103
    v_mul_f32 v23, v23, v107
    v_cvt_pk_bf16_f32 v83, v19, v23
    v_mfma_f32_32x32x16_bf16 v[84:99], v[60:63], v[156:159], v[84:99]
    ds_read_b128 v[52:55], v2 offset:44032
    buffer_store_dwordx4 v[80:83], v2, s[40:43], s13 offen offset:3072 sc1
    s_add_u32 s13, s13, 4096
    ds_read_b128 v[100:103], v119 offset:640
    ds_read_b128 v[104:107], v119 offset:656
    ds_read_b128 v[108:111], v119 offset:672
    s_waitcnt lgkmcnt(5)
    v_mfma_f32_32x32x16_bf16 v[84:99], v[40:43], v[160:163], v[84:99]
    ds_read_b128 v[56:59], v2 offset:45056
    ds_read_b128 v[124:127], v119 offset:688
    v_fma_f32 v24, v112, v24, v64
    v_fma_f32 v28, v112, v28, v68
    v_mfma_f32_32x32x16_bf16 v[84:99], v[44:47], v[164:167], v[84:99]
    ds_read_b128 v[60:63], v2 offset:46080
    buffer_load_dwordx4 a[168:171], v2, s[40:43], s22 offen offset:1024 sc1
    v_exp_f32 v64, v24
    v_fma_f32 v32, v113, v32, v72
    s_waitcnt lgkmcnt(6)
    v_mfma_f32_32x32x16_bf16 v[84:99], v[48:51], v[168:171], v[84:99]
    ds_read_b128 v[40:43], v2 offset:47104
    v_exp_f32 v68, v28
    v_fma_f32 v36, v113, v36, v76
    v_add_f32 v64, 1.0, v64
    v_mfma_f32_32x32x16_bf16 v[84:99], v[52:55], v[172:175], v[84:99]
    ds_read_b128 v[44:47], v2 offset:48128
    v_mul_f32 v32, v24, v32
    v_rcp_f32 v64, v64
    v_add_f32 v68, 1.0, v68
    s_waitcnt lgkmcnt(2)
    v_mfma_f32_32x32x16_bf16 v[84:99], v[56:59], v[176:179], v[84:99]
    ds_read_b128 v[48:51], v2 offset:49152
    v_rcp_f32 v68, v68
    v_mul_f32 v36, v28, v36
    v_mul_f32 v32, v32, v64
    v_mfma_f32_32x32x16_bf16 v[84:99], v[60:63], v[180:183], v[84:99]
    ds_read_b128 v[52:55], v2 offset:50176
    buffer_load_dwordx4 a[172:175], v2, s[40:43], s23 offen offset:1024 sc1
    v_mul_f32 v36, v36, v68
    v_cvt_pk_bf16_f32 v80, v32, v36
    v_fma_f32 v25, v112, v25, v65
    s_waitcnt lgkmcnt(2)
    v_mfma_f32_32x32x16_bf16 v[84:99], v[40:43], v[184:187], v[84:99]
    ds_read_b128 v[56:59], v2 offset:51200
    v_fma_f32 v29, v112, v29, v69
    v_exp_f32 v65, v25
    v_fma_f32 v33, v113, v33, v73
    v_mfma_f32_32x32x16_bf16 v[84:99], v[44:47], v[188:191], v[84:99]
    ds_read_b128 v[60:63], v2 offset:52224
    v_exp_f32 v69, v29
    v_fma_f32 v37, v113, v37, v77
    v_add_f32 v65, 1.0, v65
    v_mul_f32 v33, v25, v33
    s_waitcnt lgkmcnt(2)
    v_mfma_f32_32x32x16_bf16 v[84:99], v[48:51], v[192:195], v[84:99]
    ds_read_b128 v[40:43], v2 offset:53248
    v_rcp_f32 v65, v65
    v_add_f32 v69, 1.0, v69
    v_mfma_f32_32x32x16_bf16 v[84:99], v[52:55], v[196:199], v[84:99]
    ds_read_b128 v[44:47], v2 offset:54272
    buffer_load_dwordx4 a[176:179], v2, s[40:43], s22 offen offset:2048 sc1
    v_rcp_f32 v69, v69
    v_mul_f32 v37, v29, v37
    s_waitcnt lgkmcnt(2)
    v_mfma_f32_32x32x16_bf16 v[84:99], v[56:59], v[200:203], v[84:99]
    ds_read_b128 v[48:51], v2 offset:55296
    v_mul_f32 v33, v33, v65
    v_mul_f32 v37, v37, v69
    v_cvt_pk_bf16_f32 v81, v33, v37
    v_fma_f32 v26, v112, v26, v66
    v_mfma_f32_32x32x16_bf16 v[84:99], v[60:63], v[204:207], v[84:99]
    ds_read_b128 v[52:55], v2 offset:56320
    v_fma_f32 v30, v112, v30, v70
    v_exp_f32 v66, v26
    v_fma_f32 v34, v113, v34, v74
    s_waitcnt lgkmcnt(2)
    v_mfma_f32_32x32x16_bf16 v[84:99], v[40:43], v[208:211], v[84:99]
    ds_read_b128 v[56:59], v2 offset:57344
    s_waitcnt vmcnt(3)
    buffer_atomic_add v121, v7, s[40:43], s81 offen sc1
    v_mfma_f32_32x32x16_bf16 v[84:99], v[44:47], v[212:215], v[84:99]
    ds_read_b128 v[60:63], v2 offset:58368
    buffer_load_dwordx4 a[180:183], v2, s[40:43], s23 offen offset:2048 sc1
    v_exp_f32 v70, v30
    v_fma_f32 v38, v113, v38, v78
    s_waitcnt lgkmcnt(2)
    v_mfma_f32_32x32x16_bf16 v[84:99], v[48:51], v[216:219], v[84:99]
    ds_read_b128 v[40:43], v2 offset:59392
    v_add_f32 v66, 1.0, v66
    v_mul_f32 v34, v26, v34
    v_rcp_f32 v66, v66
    v_mfma_f32_32x32x16_bf16 v[84:99], v[52:55], v[220:223], v[84:99]
    ds_read_b128 v[44:47], v2 offset:60416
    v_add_f32 v70, 1.0, v70
    v_rcp_f32 v70, v70
    v_mul_f32 v38, v30, v38
    v_mul_f32 v34, v34, v66
    s_waitcnt lgkmcnt(2)
    v_mfma_f32_32x32x16_bf16 v[84:99], v[56:59], v[224:227], v[84:99]
    ds_read_b128 v[48:51], v2 offset:61440
    v_mul_f32 v38, v38, v70
    v_cvt_pk_bf16_f32 v82, v34, v38
    v_fma_f32 v27, v112, v27, v67
    v_fma_f32 v31, v112, v31, v71
    v_mfma_f32_32x32x16_bf16 v[84:99], v[60:63], v[228:231], v[84:99]
    ds_read_b128 v[52:55], v2 offset:62464
    buffer_load_dwordx4 a[184:187], v2, s[40:43], s22 offen offset:3072 sc1
    s_add_u32 s22, s22, 4096
    v_exp_f32 v67, v27
    s_waitcnt lgkmcnt(2)
    v_mfma_f32_32x32x16_bf16 v[84:99], v[40:43], v[232:235], v[84:99]
    ds_read_b128 v[56:59], v2 offset:63488
    v_fma_f32 v35, v113, v35, v75
    v_exp_f32 v71, v31
    v_fma_f32 v39, v113, v39, v79
    v_mfma_f32_32x32x16_bf16 v[84:99], v[44:47], v[236:239], v[84:99]
    ds_read_b128 v[60:63], v2 offset:64512
    v_add_f32 v67, 1.0, v67
    v_mul_f32 v35, v27, v35
    v_rcp_f32 v67, v67
    v_add_f32 v71, 1.0, v71
    s_waitcnt lgkmcnt(2)
    v_mfma_f32_32x32x16_bf16 v[84:99], v[48:51], v[240:243], v[84:99]
    ds_read_b128 v[40:43], v114 offset:0
    v_rcp_f32 v71, v71
    v_mul_f32 v39, v31, v39
    v_mul_f32 v35, v35, v67
    v_mfma_f32_32x32x16_bf16 v[84:99], v[52:55], v[244:247], v[84:99]
    ds_read_b128 v[44:47], v114 offset:1024
    buffer_load_dwordx4 a[188:191], v2, s[40:43], s23 offen offset:3072 sc1
    s_add_u32 s23, s23, 4096
    v_mul_f32 v39, v39, v71
    v_cvt_pk_bf16_f32 v83, v35, v39
    s_waitcnt lgkmcnt(2)
    v_mfma_f32_32x32x16_bf16 v[84:99], v[56:59], v[248:251], v[84:99]
    ds_read_b128 v[48:51], v114 offset:2048
    buffer_store_dwordx4 v[80:83], v2, s[40:43], s13 offen offset:0 sc1
    v_mfma_f32_32x32x16_bf16 v[84:99], v[60:63], v[252:255], v[84:99]
    ds_read_b128 v[52:55], v114 offset:3072
    s_waitcnt lgkmcnt(2)
    v_mfma_f32_32x32x16_bf16 v[8:23], v[40:43], v[128:131], 0
    ds_read_b128 v[56:59], v114 offset:4096
    v_mfma_f32_32x32x16_bf16 v[8:23], v[44:47], v[132:135], v[8:23]
    ds_read_b128 v[60:63], v114 offset:5120
    buffer_load_dwordx4 a[192:195], v2, s[40:43], s22 offen offset:0 sc1
    s_waitcnt lgkmcnt(2)
    v_mfma_f32_32x32x16_bf16 v[8:23], v[48:51], v[136:139], v[8:23]
    ds_read_b128 v[40:43], v114 offset:6144
    ds_read_b128 v[64:67], v119 offset:768
    ds_read_b128 v[68:71], v119 offset:784
    ds_read_b128 v[72:75], v119 offset:800
    ds_read_b128 v[76:79], v119 offset:816
    v_mfma_f32_32x32x16_bf16 v[8:23], v[52:55], v[140:143], v[8:23]
    ds_read_b128 v[44:47], v114 offset:7168
    v_fma_f32 v84, v112, v84, v100
    v_fma_f32 v88, v112, v88, v104
    v_exp_f32 v100, v84
    v_fma_f32 v92, v113, v92, v108
    s_waitcnt lgkmcnt(6)
    v_mfma_f32_32x32x16_bf16 v[8:23], v[56:59], v[144:147], v[8:23]
    ds_read_b128 v[48:51], v114 offset:8192
    v_exp_f32 v104, v88
    v_fma_f32 v96, v113, v96, v124
    v_add_f32 v100, 1.0, v100
    v_mfma_f32_32x32x16_bf16 v[8:23], v[60:63], v[148:151], v[8:23]
    ds_read_b128 v[52:55], v114 offset:9216
    buffer_load_dwordx4 a[196:199], v2, s[40:43], s23 offen offset:0 sc1
    v_mul_f32 v92, v84, v92
    v_rcp_f32 v100, v100
    s_waitcnt lgkmcnt(2)
    v_mfma_f32_32x32x16_bf16 v[8:23], v[40:43], v[152:155], v[8:23]
    ds_read_b128 v[56:59], v114 offset:10240
    v_add_f32 v104, 1.0, v104
    v_rcp_f32 v104, v104
    v_mul_f32 v96, v88, v96
    v_mfma_f32_32x32x16_bf16 v[8:23], v[44:47], v[156:159], v[8:23]
    ds_read_b128 v[60:63], v114 offset:11264
    v_mul_f32 v92, v92, v100
    v_mul_f32 v96, v96, v104
    v_cvt_pk_bf16_f32 v80, v92, v96
    v_fma_f32 v85, v112, v85, v101
    v_fma_f32 v89, v112, v89, v105
    s_waitcnt lgkmcnt(2)
    v_mfma_f32_32x32x16_bf16 v[8:23], v[48:51], v[160:163], v[8:23]
    ds_read_b128 v[40:43], v114 offset:12288
    v_exp_f32 v101, v85
    v_fma_f32 v93, v113, v93, v109
    v_mfma_f32_32x32x16_bf16 v[8:23], v[52:55], v[164:167], v[8:23]
    ds_read_b128 v[44:47], v114 offset:13312
    buffer_load_dwordx4 a[200:203], v2, s[40:43], s22 offen offset:1024 sc1
    v_exp_f32 v105, v89
    v_fma_f32 v97, v113, v97, v125
    s_waitcnt lgkmcnt(2)
    v_mfma_f32_32x32x16_bf16 v[8:23], v[56:59], v[168:171], v[8:23]
    ds_read_b128 v[48:51], v114 offset:14336
    v_add_f32 v101, 1.0, v101
    v_mul_f32 v93, v85, v93
    v_rcp_f32 v101, v101
    v_mfma_f32_32x32x16_bf16 v[8:23], v[60:63], v[172:175], v[8:23]
    ds_read_b128 v[52:55], v114 offset:15360
    v_add_f32 v105, 1.0, v105
    v_rcp_f32 v105, v105
    v_mul_f32 v97, v89, v97
    v_mul_f32 v93, v93, v101
    s_waitcnt lgkmcnt(2)
    v_mfma_f32_32x32x16_bf16 v[8:23], v[40:43], v[176:179], v[8:23]
    ds_read_b128 v[56:59], v114 offset:16384
    v_mul_f32 v97, v97, v105
    v_cvt_pk_bf16_f32 v81, v93, v97
    v_fma_f32 v86, v112, v86, v102
    v_fma_f32 v90, v112, v90, v106
    v_mfma_f32_32x32x16_bf16 v[8:23], v[44:47], v[180:183], v[8:23]
    ds_read_b128 v[60:63], v114 offset:17408
    buffer_load_dwordx4 a[204:207], v2, s[40:43], s23 offen offset:1024 sc1
    v_exp_f32 v102, v86
    v_fma_f32 v94, v113, v94, v110
    s_waitcnt lgkmcnt(2)
    v_mfma_f32_32x32x16_bf16 v[8:23], v[48:51], v[184:187], v[8:23]
    ds_read_b128 v[40:43], v114 offset:18432
    v_exp_f32 v106, v90
    v_fma_f32 v98, v113, v98, v126
    v_add_f32 v102, 1.0, v102
    v_mfma_f32_32x32x16_bf16 v[8:23], v[52:55], v[188:191], v[8:23]
    ds_read_b128 v[44:47], v114 offset:19456
    v_mul_f32 v94, v86, v94
    v_rcp_f32 v102, v102
    v_add_f32 v106, 1.0, v106
    s_waitcnt lgkmcnt(2)
    v_mfma_f32_32x32x16_bf16 v[8:23], v[56:59], v[192:195], v[8:23]
    ds_read_b128 v[48:51], v114 offset:20480
    v_rcp_f32 v106, v106
    v_mul_f32 v98, v90, v98
    v_mul_f32 v94, v94, v102
    v_mfma_f32_32x32x16_bf16 v[8:23], v[60:63], v[196:199], v[8:23]
    ds_read_b128 v[52:55], v114 offset:21504
    buffer_load_dwordx4 a[208:211], v2, s[40:43], s22 offen offset:2048 sc1
    v_mul_f32 v98, v98, v106
    v_cvt_pk_bf16_f32 v82, v94, v98
    v_fma_f32 v87, v112, v87, v103
    s_waitcnt lgkmcnt(2)
    v_mfma_f32_32x32x16_bf16 v[8:23], v[40:43], v[200:203], v[8:23]
    ds_read_b128 v[56:59], v114 offset:22528
    v_fma_f32 v91, v112, v91, v107
    v_exp_f32 v103, v87
    v_fma_f32 v95, v113, v95, v111
    v_mfma_f32_32x32x16_bf16 v[8:23], v[44:47], v[204:207], v[8:23]
    ds_read_b128 v[60:63], v114 offset:23552
    v_exp_f32 v107, v91
    v_fma_f32 v99, v113, v99, v127
    v_add_f32 v103, 1.0, v103
    v_mul_f32 v95, v87, v95
    s_waitcnt lgkmcnt(2)
    v_mfma_f32_32x32x16_bf16 v[8:23], v[48:51], v[208:211], v[8:23]
    ds_read_b128 v[40:43], v114 offset:24576
    v_rcp_f32 v103, v103
    v_add_f32 v107, 1.0, v107
    v_mfma_f32_32x32x16_bf16 v[8:23], v[52:55], v[212:215], v[8:23]
    ds_read_b128 v[44:47], v114 offset:25600
    buffer_load_dwordx4 a[212:215], v2, s[40:43], s23 offen offset:2048 sc1
    v_rcp_f32 v107, v107
    v_mul_f32 v99, v91, v99
    s_waitcnt lgkmcnt(2)
    v_mfma_f32_32x32x16_bf16 v[8:23], v[56:59], v[216:219], v[8:23]
    ds_read_b128 v[48:51], v114 offset:26624
    v_mul_f32 v95, v95, v103
    v_mul_f32 v99, v99, v107
    v_cvt_pk_bf16_f32 v83, v95, v99
    v_mfma_f32_32x32x16_bf16 v[8:23], v[60:63], v[220:223], v[8:23]
    ds_read_b128 v[52:55], v114 offset:27648
    buffer_store_dwordx4 v[80:83], v2, s[40:43], s13 offen offset:1024 sc1
    s_waitcnt lgkmcnt(2)
    v_mfma_f32_32x32x16_bf16 v[8:23], v[40:43], v[224:227], v[8:23]
    ds_read_b128 v[56:59], v114 offset:28672
    v_mfma_f32_32x32x16_bf16 v[8:23], v[44:47], v[228:231], v[8:23]
    ds_read_b128 v[60:63], v114 offset:29696
    buffer_load_dwordx4 a[216:219], v2, s[40:43], s22 offen offset:3072 sc1
    s_add_u32 s22, s22, 4096
    s_waitcnt lgkmcnt(2)
    v_mfma_f32_32x32x16_bf16 v[8:23], v[48:51], v[232:235], v[8:23]
    ds_read_b128 v[40:43], v114 offset:30720
    v_mfma_f32_32x32x16_bf16 v[8:23], v[52:55], v[236:239], v[8:23]
    ds_read_b128 v[44:47], v114 offset:31744
    s_waitcnt lgkmcnt(2)
    v_mfma_f32_32x32x16_bf16 v[8:23], v[56:59], v[240:243], v[8:23]
    v_mfma_f32_32x32x16_bf16 v[8:23], v[60:63], v[244:247], v[8:23]
    buffer_load_dwordx4 a[220:223], v2, s[40:43], s23 offen offset:3072 sc1
    s_add_u32 s23, s23, 4096
    s_waitcnt lgkmcnt(0)
    v_mfma_f32_32x32x16_bf16 v[8:23], v[40:43], v[248:251], v[8:23]
    v_mfma_f32_32x32x16_bf16 v[8:23], v[44:47], v[252:255], v[8:23]
    s_buffer_load_dword s34, s[40:43], s15 offset:0 glc
    s_buffer_load_dword s35, s[40:43], s15 offset:512 glc
    s_nop 9
    v_fma_f32 v8, v112, v8, v64
    v_fma_f32 v12, v112, v12, v68
    v_exp_f32 v64, v8
    v_fma_f32 v16, v113, v16, v72
    v_exp_f32 v68, v12
    v_fma_f32 v20, v113, v20, v76
    v_add_f32 v64, 1.0, v64
    v_mul_f32 v16, v8, v16
    v_rcp_f32 v64, v64
    v_add_f32 v68, 1.0, v68
    v_rcp_f32 v68, v68
    v_mul_f32 v20, v12, v20
    v_mul_f32 v16, v16, v64
    v_mul_f32 v20, v20, v68
    v_cvt_pk_bf16_f32 v80, v16, v20
    v_fma_f32 v9, v112, v9, v65
    v_fma_f32 v13, v112, v13, v69
    v_exp_f32 v65, v9
    v_fma_f32 v17, v113, v17, v73
    v_exp_f32 v69, v13
    v_fma_f32 v21, v113, v21, v77
    v_add_f32 v65, 1.0, v65
    v_mul_f32 v17, v9, v17
    v_rcp_f32 v65, v65
    v_add_f32 v69, 1.0, v69
    v_rcp_f32 v69, v69
    v_mul_f32 v21, v13, v21
    v_mul_f32 v17, v17, v65
    v_mul_f32 v21, v21, v69
    v_cvt_pk_bf16_f32 v81, v17, v21
    v_fma_f32 v10, v112, v10, v66
    v_fma_f32 v14, v112, v14, v70
    v_exp_f32 v66, v10
    v_fma_f32 v18, v113, v18, v74
    v_exp_f32 v70, v14
    v_fma_f32 v22, v113, v22, v78
    v_add_f32 v66, 1.0, v66
    v_mul_f32 v18, v10, v18
    v_rcp_f32 v66, v66
    v_add_f32 v70, 1.0, v70
    v_rcp_f32 v70, v70
    v_mul_f32 v22, v14, v22
    v_mul_f32 v18, v18, v66
    v_mul_f32 v22, v22, v70
    v_cvt_pk_bf16_f32 v82, v18, v22
    v_fma_f32 v11, v112, v11, v67
    v_fma_f32 v15, v112, v15, v71
    v_exp_f32 v67, v11
    v_fma_f32 v19, v113, v19, v75
    v_exp_f32 v71, v15
    v_fma_f32 v23, v113, v23, v79
    v_add_f32 v67, 1.0, v67
    v_mul_f32 v19, v11, v19
    v_rcp_f32 v67, v67
    v_add_f32 v71, 1.0, v71
    v_rcp_f32 v71, v71
    v_mul_f32 v23, v15, v23
    v_mul_f32 v19, v19, v67
    v_mul_f32 v23, v23, v71
    v_cvt_pk_bf16_f32 v83, v19, v23
    buffer_store_dwordx4 v[80:83], v2, s[40:43], s13 offen offset:2048 sc1
    v_and_b32 v6, 31, v0
    v_bfe_u32 v100, v0, 5, 1
    s_mov_b32 s9, 33792
    v_lshlrev_b32 v5, 2, v6
    v_mad_u32_u24 v5, v100, s9, v5
    v_lshlrev_b32 v6, 10, v6
    v_lshl_add_u32 v6, v100, 4, v6
    s_lshl_b32 s9, s3, 7
    s_add_u32 s9, s9, 160768
    v_lshl_add_u32 v100, v100, 5, s9
    ds_read_b128 v[16:19], v100 offset:0
    ds_read_b128 v[20:23], v100 offset:16
    ds_read_b128 v[24:27], v100 offset:64
    ds_read_b128 v[28:31], v100 offset:80
    s_xor_b32 s4, s3, 1
    s_mul_i32 s4, s4, 12288
    s_add_u32 s4, s4, 98304
    v_add_u32 v97, s4, v2
    s_xor_b32 s4, s3, 2
    s_mul_i32 s4, s4, 12288
    s_add_u32 s4, s4, 102400
    v_add_u32 v98, s4, v2
    s_xor_b32 s4, s3, 3
    s_mul_i32 s4, s4, 12288
    s_add_u32 s4, s4, 106496
    v_add_u32 v99, s4, v2
    s_mul_i32 s4, s3, 12288
    s_add_u32 s4, s4, 98304
    v_add_u32 v96, s4, v2
    s_mul_i32 s4, s3, 12288
    s_add_u32 s4, s4, 98304
    v_bfe_u32 v101, v0, 5, 1
    v_bfe_u32 v102, v0, 1, 2
    v_xor_b32 v101, v101, v102
    v_and_b32 v102, 31, v0
    v_lshl_add_u32 v102, v102, 6, s4
    v_lshl_add_u32 v101, v101, 4, v102
    v_xor_b32 v102, 32, v101
    v_bfe_u32 v103, v0, 3, 2
    v_and_b32 v6, 3, v0
    v_xor_b32 v103, v103, v6
    v_bfe_u32 v104, v0, 2, 4
    v_lshlrev_b32 v6, 4, v6
    v_lshl_add_u32 v6, v104, 10, v6
    v_lshl_add_u32 v104, v104, 6, s4
    v_lshl_add_u32 v103, v103, 4, v104
    s_add_u32 s9, s8, 16384
    s_waitcnt vmcnt(0)
    buffer_atomic_add v121, v7, s[40:43], s81 offen offset:512 sc1
    s_waitcnt lgkmcnt(0)
    s_cmp_eq_u32 s35, 8
    s_cbranch_scc1 Lst0
    s_cmp_eq_u32 s34, 8
    s_cbranch_scc1 Lsax
    s_mov_b32 s86, 0
Lsas:
    s_buffer_load_dword s34, s[40:43], s15 offset:0 glc
    s_add_u32 s86, s86, 1
    s_waitcnt lgkmcnt(0)
    s_cmp_eq_u32 s34, 8
    s_cbranch_scc1 Lsax
    s_cmp_lt_u32 s86, 64
    s_cbranch_scc1 Lsas
    s_mov_b32 s86, 0
Lsa:
    buffer_load_dword v123, off, s[40:43], s15 offset:0 sc1
    s_add_u32 s86, s86, 1
    s_waitcnt vmcnt(0)
    v_readfirstlane_b32 s6, v123
    s_cmp_gt_u32 s86, 200000
    s_cbranch_scc1 Lsax
    s_cmp_lg_u32 s6, 8
    s_cbranch_scc1 Lsa
Lsax:
    s_buffer_load_dword s35, s[40:43], s15 offset:512 glc
    buffer_load_dwordx4 v[128:131], v2, s[40:43], s24 offen offset:0 sc1
    buffer_load_dwordx4 v[132:135], v2, s[40:43], s74 offen offset:0 sc1
    buffer_load_dwordx4 v[136:139], v2, s[40:43], s25 offen offset:3072 sc1
    buffer_load_dwordx4 v[140:143], v2, s[40:43], s75 offen offset:3072 sc1
    buffer_load_dwordx4 v[144:147], v2, s[40:43], s27 offen offset:2048 sc1
    buffer_load_dwordx4 v[148:151], v2, s[40:43], s77 offen offset:2048 sc1
    buffer_load_dwordx4 v[152:155], v2, s[40:43], s29 offen offset:1024 sc1
    buffer_load_dwordx4 v[156:159], v2, s[40:43], s79 offen offset:1024 sc1
    buffer_load_dwordx4 v[160:163], v2, s[40:43], s24 offen offset:1024 sc1
    buffer_load_dwordx4 v[164:167], v2, s[40:43], s74 offen offset:1024 sc1
    s_waitcnt vmcnt(9)
    v_mfma_f32_32x32x16_bf16 v[32:47], a[0:3], v[128:131], 0
    v_mfma_f32_32x32x16_bf16 v[64:79], a[4:7], v[128:131], 0
    buffer_load_dwordx4 v[168:171], v2, s[40:43], s26 offen offset:0 sc1
    s_waitcnt vmcnt(9)
    v_mfma_f32_32x32x16_bf16 v[48:63], a[0:3], v[132:135], 0
    v_mfma_f32_32x32x16_bf16 v[80:95], a[4:7], v[132:135], 0
    buffer_load_dwordx4 v[172:175], v2, s[40:43], s76 offen offset:0 sc1
    s_waitcnt vmcnt(9)
    v_mfma_f32_32x32x16_bf16 v[32:47], a[56:59], v[136:139], v[32:47]
    v_mfma_f32_32x32x16_bf16 v[64:79], a[60:63], v[136:139], v[64:79]
    buffer_load_dwordx4 v[176:179], v2, s[40:43], s27 offen offset:3072 sc1
    s_waitcnt vmcnt(9)
    v_mfma_f32_32x32x16_bf16 v[48:63], a[56:59], v[140:143], v[48:63]
    v_mfma_f32_32x32x16_bf16 v[80:95], a[60:63], v[140:143], v[80:95]
    buffer_load_dwordx4 v[180:183], v2, s[40:43], s77 offen offset:3072 sc1
    s_waitcnt lgkmcnt(0)
    s_cmp_eq_u32 s35, 8
    s_cbranch_scc1 Lst4
    s_buffer_load_dword s35, s[40:43], s15 offset:512 glc
    s_waitcnt vmcnt(9)
    v_mfma_f32_32x32x16_bf16 v[32:47], a[112:115], v[144:147], v[32:47]
    v_mfma_f32_32x32x16_bf16 v[64:79], a[116:119], v[144:147], v[64:79]
    buffer_load_dwordx4 v[184:187], v2, s[40:43], s29 offen offset:2048 sc1
    s_waitcnt vmcnt(9)
    v_mfma_f32_32x32x16_bf16 v[48:63], a[112:115], v[148:151], v[48:63]
    v_mfma_f32_32x32x16_bf16 v[80:95], a[116:119], v[148:151], v[80:95]
    buffer_load_dwordx4 v[188:191], v2, s[40:43], s79 offen offset:2048 sc1
    s_waitcnt vmcnt(9)
    v_mfma_f32_32x32x16_bf16 v[32:47], a[168:171], v[152:155], v[32:47]
    v_mfma_f32_32x32x16_bf16 v[64:79], a[172:175], v[152:155], v[64:79]
    buffer_load_dwordx4 v[192:195], v2, s[40:43], s24 offen offset:2048 sc1
    s_waitcnt vmcnt(9)
    v_mfma_f32_32x32x16_bf16 v[48:63], a[168:171], v[156:159], v[48:63]
    v_mfma_f32_32x32x16_bf16 v[80:95], a[172:175], v[156:159], v[80:95]
    buffer_load_dwordx4 v[196:199], v2, s[40:43], s74 offen offset:2048 sc1
    s_waitcnt lgkmcnt(0)
    s_cmp_eq_u32 s35, 8
    s_cbranch_scc1 Lst8
    s_buffer_load_dword s35, s[40:43], s15 offset:512 glc
    s_waitcnt vmcnt(9)
    v_mfma_f32_32x32x16_bf16 v[32:47], a[8:11], v[160:163], v[32:47]
    v_mfma_f32_32x32x16_bf16 v[64:79], a[12:15], v[160:163], v[64:79]
    buffer_load_dwordx4 v[200:203], v2, s[40:43], s26 offen offset:1024 sc1
    s_waitcnt vmcnt(9)
    v_mfma_f32_32x32x16_bf16 v[48:63], a[8:11], v[164:167], v[48:63]
    v_mfma_f32_32x32x16_bf16 v[80:95], a[12:15], v[164:167], v[80:95]
    buffer_load_dwordx4 v[204:207], v2, s[40:43], s76 offen offset:1024 sc1
    s_waitcnt vmcnt(9)
    v_mfma_f32_32x32x16_bf16 v[32:47], a[64:67], v[168:171], v[32:47]
    v_mfma_f32_32x32x16_bf16 v[64:79], a[68:71], v[168:171], v[64:79]
    buffer_load_dwordx4 v[208:211], v2, s[40:43], s28 offen offset:0 sc1
    s_waitcnt vmcnt(9)
    v_mfma_f32_32x32x16_bf16 v[48:63], a[64:67], v[172:175], v[48:63]
    v_mfma_f32_32x32x16_bf16 v[80:95], a[68:71], v[172:175], v[80:95]
    buffer_load_dwordx4 v[212:215], v2, s[40:43], s78 offen offset:0 sc1
    s_waitcnt lgkmcnt(0)
    s_cmp_eq_u32 s35, 8
    s_cbranch_scc1 Lst12
    s_buffer_load_dword s35, s[40:43], s15 offset:512 glc
    s_waitcnt vmcnt(9)
    v_mfma_f32_32x32x16_bf16 v[32:47], a[120:123], v[176:179], v[32:47]
    v_mfma_f32_32x32x16_bf16 v[64:79], a[124:127], v[176:179], v[64:79]
    buffer_load_dwordx4 v[216:219], v2, s[40:43], s29 offen offset:3072 sc1
    s_waitcnt vmcnt(9)
    v_mfma_f32_32x32x16_bf16 v[48:63], a[120:123], v[180:183], v[48:63]
    v_mfma_f32_32x32x16_bf16 v[80:95], a[124:127], v[180:183], v[80:95]
    buffer_load_dwordx4 v[220:223], v2, s[40:43], s79 offen offset:3072 sc1
    s_waitcnt vmcnt(9)
    v_mfma_f32_32x32x16_bf16 v[32:47], a[176:179], v[184:187], v[32:47]
    v_mfma_f32_32x32x16_bf16 v[64:79], a[180:183], v[184:187], v[64:79]
    buffer_load_dwordx4 v[224:227], v2, s[40:43], s24 offen offset:3072 sc1
    s_waitcnt vmcnt(9)
    v_mfma_f32_32x32x16_bf16 v[48:63], a[176:179], v[188:191], v[48:63]
    v_mfma_f32_32x32x16_bf16 v[80:95], a[180:183], v[188:191], v[80:95]
    buffer_load_dwordx4 v[228:231], v2, s[40:43], s74 offen offset:3072 sc1
    s_waitcnt lgkmcnt(0)
    s_cmp_eq_u32 s35, 8
    s_cbranch_scc1 Lst16
    s_buffer_load_dword s35, s[40:43], s15 offset:512 glc
    s_waitcnt vmcnt(9)
    v_mfma_f32_32x32x16_bf16 v[32:47], a[16:19], v[192:195], v[32:47]
    v_mfma_f32_32x32x16_bf16 v[64:79], a[20:23], v[192:195], v[64:79]
    buffer_load_dwordx4 v[232:235], v2, s[40:43], s26 offen offset:2048 sc1
    s_waitcnt vmcnt(9)
    v_mfma_f32_32x32x16_bf16 v[48:63], a[16:19], v[196:199], v[48:63]
    v_mfma_f32_32x32x16_bf16 v[80:95], a[20:23], v[196:199], v[80:95]
    buffer_load_dwordx4 v[236:239], v2, s[40:43], s76 offen offset:2048 sc1
    s_waitcnt vmcnt(9)
    v_mfma_f32_32x32x16_bf16 v[32:47], a[72:75], v[200:203], v[32:47]
    v_mfma_f32_32x32x16_bf16 v[64:79], a[76:79], v[200:203], v[64:79]
    buffer_load_dwordx4 v[240:243], v2, s[40:43], s28 offen offset:1024 sc1
    s_waitcnt vmcnt(9)
    v_mfma_f32_32x32x16_bf16 v[48:63], a[72:75], v[204:207], v[48:63]
    v_mfma_f32_32x32x16_bf16 v[80:95], a[76:79], v[204:207], v[80:95]
    buffer_load_dwordx4 v[244:247], v2, s[40:43], s78 offen offset:1024 sc1
    s_waitcnt lgkmcnt(0)
    s_cmp_eq_u32 s35, 8
    s_cbranch_scc1 Lst20
    s_buffer_load_dword s35, s[40:43], s15 offset:512 glc
    s_waitcnt vmcnt(9)
    v_mfma_f32_32x32x16_bf16 v[32:47], a[128:131], v[208:211], v[32:47]
    v_mfma_f32_32x32x16_bf16 v[64:79], a[132:135], v[208:211], v[64:79]
    buffer_load_dwordx4 v[248:251], v2, s[40:43], s30 offen offset:0 sc1
    s_waitcnt vmcnt(9)
    v_mfma_f32_32x32x16_bf16 v[48:63], a[128:131], v[212:215], v[48:63]
    v_mfma_f32_32x32x16_bf16 v[80:95], a[132:135], v[212:215], v[80:95]
    buffer_load_dwordx4 v[252:255], v2, s[40:43], s80 offen offset:0 sc1
    s_waitcnt vmcnt(9)
    v_mfma_f32_32x32x16_bf16 v[32:47], a[184:187], v[216:219], v[32:47]
    v_mfma_f32_32x32x16_bf16 v[64:79], a[188:191], v[216:219], v[64:79]
    s_waitcnt vmcnt(8)
    v_mfma_f32_32x32x16_bf16 v[48:63], a[184:187], v[220:223], v[48:63]
    v_mfma_f32_32x32x16_bf16 v[80:95], a[188:191], v[220:223], v[80:95]
    s_waitcnt lgkmcnt(0)
    s_cmp_eq_u32 s35, 8
    s_cbranch_scc1 Lst24
    s_buffer_load_dword s35, s[40:43], s15 offset:512 glc
    s_waitcnt vmcnt(7)
    v_mfma_f32_32x32x16_bf16 v[32:47], a[24:27], v[224:227], v[32:47]
    v_mfma_f32_32x32x16_bf16 v[64:79], a[28:31], v[224:227], v[64:79]
    s_waitcnt vmcnt(6)
    v_mfma_f32_32x32x16_bf16 v[48:63], a[24:27], v[228:231], v[48:63]
    v_mfma_f32_32x32x16_bf16 v[80:95], a[28:31], v[228:231], v[80:95]
    s_waitcnt vmcnt(5)
    v_mfma_f32_32x32x16_bf16 v[32:47], a[80:83], v[232:235], v[32:47]
    v_mfma_f32_32x32x16_bf16 v[64:79], a[84:87], v[232:235], v[64:79]
    s_waitcnt vmcnt(4)
    v_mfma_f32_32x32x16_bf16 v[48:63], a[80:83], v[236:239], v[48:63]
    v_mfma_f32_32x32x16_bf16 v[80:95], a[84:87], v[236:239], v[80:95]
    s_waitcnt lgkmcnt(0)
    s_cmp_eq_u32 s35, 8
    s_cbranch_scc1 Lst28
    s_mov_b32 s86, 0
Lsbs:
    s_buffer_load_dword s35, s[40:43], s15 offset:512 glc
    s_add_u32 s86, s86, 1
    s_waitcnt lgkmcnt(0)
    s_cmp_eq_u32 s35, 8
    s_cbranch_scc1 Lst28
    s_cmp_lt_u32 s86, 64
    s_cbranch_scc1 Lsbs
    s_mov_b32 s86, 0
Lsb:
    buffer_load_dword v123, off, s[40:43], s15 offset:512 sc1
    s_add_u32 s86, s86, 1
    s_waitcnt vmcnt(0)
    v_readfirstlane_b32 s6, v123
    s_cmp_gt_u32 s86, 200000
    s_cbranch_scc1 Lsbx
    s_cmp_lg_u32 s6, 8
    s_cbranch_scc1 Lsb
Lsbx:
Lst28:
    buffer_load_dwordx4 v[128:131], v2, s[40:43], s25 offen offset:0 sc1
    buffer_load_dwordx4 v[132:135], v2, s[40:43], s75 offen offset:0 sc1
    buffer_load_dwordx4 v[136:139], v2, s[40:43], s26 offen offset:3072 sc1
    buffer_load_dwordx4 v[140:143], v2, s[40:43], s76 offen offset:3072 sc1
    buffer_load_dwordx4 v[144:147], v2, s[40:43], s28 offen offset:2048 sc1
    buffer_load_dwordx4 v[148:151], v2, s[40:43], s78 offen offset:2048 sc1
    buffer_load_dwordx4 v[152:155], v2, s[40:43], s30 offen offset:1024 sc1
    buffer_load_dwordx4 v[156:159], v2, s[40:43], s80 offen offset:1024 sc1
    buffer_load_dwordx4 v[160:163], v2, s[40:43], s25 offen offset:1024 sc1
    buffer_load_dwordx4 v[164:167], v2, s[40:43], s75 offen offset:1024 sc1
    s_branch Lsp28
Lst24:
    buffer_load_dwordx4 v[128:131], v2, s[40:43], s25 offen offset:0 sc1
    buffer_load_dwordx4 v[132:135], v2, s[40:43], s75 offen offset:0 sc1
    buffer_load_dwordx4 v[136:139], v2, s[40:43], s26 offen offset:3072 sc1
    buffer_load_dwordx4 v[140:143], v2, s[40:43], s76 offen offset:3072 sc1
    buffer_load_dwordx4 v[144:147], v2, s[40:43], s28 offen offset:2048 sc1
    buffer_load_dwordx4 v[148:151], v2, s[40:43], s78 offen offset:2048 sc1
    s_branch Lsp24
Lst20:
    buffer_load_dwordx4 v[248:251], v2, s[40:43], s30 offen offset:0 sc1
    buffer_load_dwordx4 v[252:255], v2, s[40:43], s80 offen offset:0 sc1
    buffer_load_dwordx4 v[128:131], v2, s[40:43], s25 offen offset:0 sc1
    buffer_load_dwordx4 v[132:135], v2, s[40:43], s75 offen offset:0 sc1
    s_branch Lsp20
Lst16:
    buffer_load_dwordx4 v[232:235], v2, s[40:43], s26 offen offset:2048 sc1
    buffer_load_dwordx4 v[236:239], v2, s[40:43], s76 offen offset:2048 sc1
    buffer_load_dwordx4 v[240:243], v2, s[40:43], s28 offen offset:1024 sc1
    buffer_load_dwordx4 v[244:247], v2, s[40:43], s78 offen offset:1024 sc1
    s_branch Lsp16
Lst12:
    buffer_load_dwordx4 v[216:219], v2, s[40:43], s29 offen offset:3072 sc1
    buffer_load_dwordx4 v[220:223], v2, s[40:43], s79 offen offset:3072 sc1
    buffer_load_dwordx4 v[224:227], v2, s[40:43], s24 offen offset:3072 sc1
    buffer_load_dwordx4 v[228:231], v2, s[40:43], s74 offen offset:3072 sc1
    s_branch Lsp12
Lst8:
    buffer_load_dwordx4 v[200:203], v2, s[40:43], s26 offen offset:1024 sc1
    buffer_load_dwordx4 v[204:207], v2, s[40:43], s76 offen offset:1024 sc1
    buffer_load_dwordx4 v[208:211], v2, s[40:43], s28 offen offset:0 sc1
    buffer_load_dwordx4 v[212:215], v2, s[40:43], s78 offen offset:0 sc1
    s_branch Lsp8
Lst4:
    buffer_load_dwordx4 v[184:187], v2, s[40:43], s29 offen offset:2048 sc1
    buffer_load_dwordx4 v[188:191], v2, s[40:43], s79 offen offset:2048 sc1
    buffer_load_dwordx4 v[192:195], v2, s[40:43], s24 offen offset:2048 sc1
    buffer_load_dwordx4 v[196:199], v2, s[40:43], s74 offen offset:2048 sc1
    s_branch Lsp4
Lst0:
    buffer_load_dwordx4 v[128:131], v2, s[40:43], s24 offen offset:0 sc1
    buffer_load_dwordx4 v[132:135], v2, s[40:43], s74 offen offset:0 sc1
    buffer_load_dwordx4 v[136:139], v2, s[40:43], s25 offen offset:3072 sc1
    buffer_load_dwordx4 v[140:143], v2, s[40:43], s75 offen offset:3072 sc1
    buffer_load_dwordx4 v[144:147], v2, s[40:43], s27 offen offset:2048 sc1
    buffer_load_dwordx4 v[148:151], v2, s[40:43], s77 offen offset:2048 sc1
    buffer_load_dwordx4 v[152:155], v2, s[40:43], s29 offen offset:1024 sc1
    buffer_load_dwordx4 v[156:159], v2, s[40:43], s79 offen offset:1024 sc1
    buffer_load_dwordx4 v[160:163], v2, s[40:43], s24 offen offset:1024 sc1
    buffer_load_dwordx4 v[164:167], v2, s[40:43], s74 offen offset:1024 sc1
    buffer_load_dwordx4 v[168:171], v2, s[40:43], s26 offen offset:0 sc1
    buffer_load_dwordx4 v[172:175], v2, s[40:43], s76 offen offset:0 sc1
    buffer_load_dwordx4 v[176:179], v2, s[40:43], s27 offen offset:3072 sc1
    buffer_load_dwordx4 v[180:183], v2, s[40:43], s77 offen offset:3072 sc1
    s_waitcnt vmcnt(13)
    v_mfma_f32_32x32x16_bf16 v[32:47], a[0:3], v[128:131], 0
    v_mfma_f32_32x32x16_bf16 v[64:79], a[4:7], v[128:131], 0
    buffer_load_dwordx4 v[184:187], v2, s[40:43], s29 offen offset:2048 sc1
    s_waitcnt vmcnt(13)
    v_mfma_f32_32x32x16_bf16 v[48:63], a[0:3], v[132:135], 0
    v_mfma_f32_32x32x16_bf16 v[80:95], a[4:7], v[132:135], 0
    buffer_load_dwordx4 v[188:191], v2, s[40:43], s79 offen offset:2048 sc1
    s_waitcnt vmcnt(13)
    v_mfma_f32_32x32x16_bf16 v[32:47], a[56:59], v[136:139], v[32:47]
    v_mfma_f32_32x32x16_bf16 v[64:79], a[60:63], v[136:139], v[64:79]
    buffer_load_dwordx4 v[192:195], v2, s[40:43], s24 offen offset:2048 sc1
    s_waitcnt vmcnt(13)
    v_mfma_f32_32x32x16_bf16 v[48:63], a[56:59], v[140:143], v[48:63]
    v_mfma_f32_32x32x16_bf16 v[80:95], a[60:63], v[140:143], v[80:95]
    buffer_load_dwordx4 v[196:199], v2, s[40:43], s74 offen offset:2048 sc1
Lsp4:
    s_waitcnt vmcnt(13)
    v_mfma_f32_32x32x16_bf16 v[32:47], a[112:115], v[144:147], v[32:47]
    v_mfma_f32_32x32x16_bf16 v[64:79], a[116:119], v[144:147], v[64:79]
    buffer_load_dwordx4 v[200:203], v2, s[40:43], s26 offen offset:1024 sc1
    s_waitcnt vmcnt(13)
    v_mfma_f32_32x32x16_bf16 v[48:63], a[112:115], v[148:151], v[48:63]
    v_mfma_f32_32x32x16_bf16 v[80:95], a[116:119], v[148:151], v[80:95]
    buffer_load_dwordx4 v[204:207], v2, s[40:43], s76 offen offset:1024 sc1
    s_waitcnt vmcnt(13)
    v_mfma_f32_32x32x16_bf16 v[32:47], a[168:171], v[152:155], v[32:47]
    v_mfma_f32_32x32x16_bf16 v[64:79], a[172:175], v[152:155], v[64:79]
    buffer_load_dwordx4 v[208:211], v2, s[40:43], s28 offen offset:0 sc1
    s_waitcnt vmcnt(13)
    v_mfma_f32_32x32x16_bf16 v[48:63], a[168:171], v[156:159], v[48:63]
    v_mfma_f32_32x32x16_bf16 v[80:95], a[172:175], v[156:159], v[80:95]
    buffer_load_dwordx4 v[212:215], v2, s[40:43], s78 offen offset:0 sc1
Lsp8:
    s_waitcnt vmcnt(13)
    v_mfma_f32_32x32x16_bf16 v[32:47], a[8:11], v[160:163], v[32:47]
    v_mfma_f32_32x32x16_bf16 v[64:79], a[12:15], v[160:163], v[64:79]
    buffer_load_dwordx4 v[216:219], v2, s[40:43], s29 offen offset:3072 sc1
    s_waitcnt vmcnt(13)
    v_mfma_f32_32x32x16_bf16 v[48:63], a[8:11], v[164:167], v[48:63]
    v_mfma_f32_32x32x16_bf16 v[80:95], a[12:15], v[164:167], v[80:95]
    buffer_load_dwordx4 v[220:223], v2, s[40:43], s79 offen offset:3072 sc1
    s_waitcnt vmcnt(13)
    v_mfma_f32_32x32x16_bf16 v[32:47], a[64:67], v[168:171], v[32:47]
    v_mfma_f32_32x32x16_bf16 v[64:79], a[68:71], v[168:171], v[64:79]
    buffer_load_dwordx4 v[224:227], v2, s[40:43], s24 offen offset:3072 sc1
    s_waitcnt vmcnt(13)
    v_mfma_f32_32x32x16_bf16 v[48:63], a[64:67], v[172:175], v[48:63]
    v_mfma_f32_32x32x16_bf16 v[80:95], a[68:71], v[172:175], v[80:95]
    buffer_load_dwordx4 v[228:231], v2, s[40:43], s74 offen offset:3072 sc1
Lsp12:
    s_waitcnt vmcnt(13)
    v_mfma_f32_32x32x16_bf16 v[32:47], a[120:123], v[176:179], v[32:47]
    v_mfma_f32_32x32x16_bf16 v[64:79], a[124:127], v[176:179], v[64:79]
    buffer_load_dwordx4 v[232:235], v2, s[40:43], s26 offen offset:2048 sc1
    s_waitcnt vmcnt(13)
    v_mfma_f32_32x32x16_bf16 v[48:63], a[120:123], v[180:183], v[48:63]
    v_mfma_f32_32x32x16_bf16 v[80:95], a[124:127], v[180:183], v[80:95]
    buffer_load_dwordx4 v[236:239], v2, s[40:43], s76 offen offset:2048 sc1
    s_waitcnt vmcnt(13)
    v_mfma_f32_32x32x16_bf16 v[32:47], a[176:179], v[184:187], v[32:47]
    v_mfma_f32_32x32x16_bf16 v[64:79], a[180:183], v[184:187], v[64:79]
    buffer_load_dwordx4 v[240:243], v2, s[40:43], s28 offen offset:1024 sc1
    s_waitcnt vmcnt(13)
    v_mfma_f32_32x32x16_bf16 v[48:63], a[176:179], v[188:191], v[48:63]
    v_mfma_f32_32x32x16_bf16 v[80:95], a[180:183], v[188:191], v[80:95]
    buffer_load_dwordx4 v[244:247], v2, s[40:43], s78 offen offset:1024 sc1
Lsp16:
    s_waitcnt vmcnt(13)
    v_mfma_f32_32x32x16_bf16 v[32:47], a[16:19], v[192:195], v[32:47]
    v_mfma_f32_32x32x16_bf16 v[64:79], a[20:23], v[192:195], v[64:79]
    buffer_load_dwordx4 v[248:251], v2, s[40:43], s30 offen offset:0 sc1
    s_waitcnt vmcnt(13)
    v_mfma_f32_32x32x16_bf16 v[48:63], a[16:19], v[196:199], v[48:63]
    v_mfma_f32_32x32x16_bf16 v[80:95], a[20:23], v[196:199], v[80:95]
    buffer_load_dwordx4 v[252:255], v2, s[40:43], s80 offen offset:0 sc1
    s_waitcnt vmcnt(13)
    v_mfma_f32_32x32x16_bf16 v[32:47], a[72:75], v[200:203], v[32:47]
    v_mfma_f32_32x32x16_bf16 v[64:79], a[76:79], v[200:203], v[64:79]
    buffer_load_dwordx4 v[128:131], v2, s[40:43], s25 offen offset:0 sc1
    s_waitcnt vmcnt(13)
    v_mfma_f32_32x32x16_bf16 v[48:63], a[72:75], v[204:207], v[48:63]
    v_mfma_f32_32x32x16_bf16 v[80:95], a[76:79], v[204:207], v[80:95]
    buffer_load_dwordx4 v[132:135], v2, s[40:43], s75 offen offset:0 sc1
Lsp20:
    s_waitcnt vmcnt(13)
    v_mfma_f32_32x32x16_bf16 v[32:47], a[128:131], v[208:211], v[32:47]
    v_mfma_f32_32x32x16_bf16 v[64:79], a[132:135], v[208:211], v[64:79]
    buffer_load_dwordx4 v[136:139], v2, s[40:43], s26 offen offset:3072 sc1
    s_waitcnt vmcnt(13)
    v_mfma_f32_32x32x16_bf16 v[48:63], a[128:131], v[212:215], v[48:63]
    v_mfma_f32_32x32x16_bf16 v[80:95], a[132:135], v[212:215], v[80:95]
    buffer_load_dwordx4 v[140:143], v2, s[40:43], s76 offen offset:3072 sc1
    s_waitcnt vmcnt(13)
    v_mfma_f32_32x32x16_bf16 v[32:47], a[184:187], v[216:219], v[32:47]
    v_mfma_f32_32x32x16_bf16 v[64:79], a[188:191], v[216:219], v[64:79]
    buffer_load_dwordx4 v[144:147], v2, s[40:43], s28 offen offset:2048 sc1
    s_waitcnt vmcnt(13)
    v_mfma_f32_32x32x16_bf16 v[48:63], a[184:187], v[220:223], v[48:63]
    v_mfma_f32_32x32x16_bf16 v[80:95], a[188:191], v[220:223], v[80:95]
    buffer_load_dwordx4 v[148:151], v2, s[40:43], s78 offen offset:2048 sc1
Lsp24:
    s_waitcnt vmcnt(13)
    v_mfma_f32_32x32x16_bf16 v[32:47], a[24:27], v[224:227], v[32:47]
    v_mfma_f32_32x32x16_bf16 v[64:79], a[28:31], v[224:227], v[64:79]
    buffer_load_dwordx4 v[152:155], v2, s[40:43], s30 offen offset:1024 sc1
    s_waitcnt vmcnt(13)
    v_mfma_f32_32x32x16_bf16 v[48:63], a[24:27], v[228:231], v[48:63]
    v_mfma_f32_32x32x16_bf16 v[80:95], a[28:31], v[228:231], v[80:95]
    buffer_load_dwordx4 v[156:159], v2, s[40:43], s80 offen offset:1024 sc1
    s_waitcnt vmcnt(13)
    v_mfma_f32_32x32x16_bf16 v[32:47], a[80:83], v[232:235], v[32:47]
    v_mfma_f32_32x32x16_bf16 v[64:79], a[84:87], v[232:235], v[64:79]
    buffer_load_dwordx4 v[160:163], v2, s[40:43], s25 offen offset:1024 sc1
    s_waitcnt vmcnt(13)
    v_mfma_f32_32x32x16_bf16 v[48:63], a[80:83], v[236:239], v[48:63]
    v_mfma_f32_32x32x16_bf16 v[80:95], a[84:87], v[236:239], v[80:95]
    buffer_load_dwordx4 v[164:167], v2, s[40:43], s75 offen offset:1024 sc1
Lsp28:
    s_waitcnt vmcnt(13)
    v_mfma_f32_32x32x16_bf16 v[32:47], a[136:139], v[240:243], v[32:47]
    v_mfma_f32_32x32x16_bf16 v[64:79], a[140:143], v[240:243], v[64:79]
    buffer_load_dwordx4 v[168:171], v2, s[40:43], s27 offen offset:0 sc1
    s_waitcnt vmcnt(13)
    v_mfma_f32_32x32x16_bf16 v[48:63], a[136:139], v[244:247], v[48:63]
    v_mfma_f32_32x32x16_bf16 v[80:95], a[140:143], v[244:247], v[80:95]
    buffer_load_dwordx4 v[172:175], v2, s[40:43], s77 offen offset:0 sc1
    s_waitcnt vmcnt(13)
    v_mfma_f32_32x32x16_bf16 v[32:47], a[192:195], v[248:251], v[32:47]
    v_mfma_f32_32x32x16_bf16 v[64:79], a[196:199], v[248:251], v[64:79]
    buffer_load_dwordx4 v[176:179], v2, s[40:43], s28 offen offset:3072 sc1
    s_waitcnt vmcnt(13)
    v_mfma_f32_32x32x16_bf16 v[48:63], a[192:195], v[252:255], v[48:63]
    v_mfma_f32_32x32x16_bf16 v[80:95], a[196:199], v[252:255], v[80:95]
    buffer_load_dwordx4 v[180:183], v2, s[40:43], s78 offen offset:3072 sc1
    s_waitcnt vmcnt(13)
    v_mfma_f32_32x32x16_bf16 v[32:47], a[32:35], v[128:131], v[32:47]
    v_mfma_f32_32x32x16_bf16 v[64:79], a[36:39], v[128:131], v[64:79]
    buffer_load_dwordx4 v[184:187], v2, s[40:43], s80 offen offset:2048 sc1
    s_waitcnt vmcnt(13)
    v_mfma_f32_32x32x16_bf16 v[48:63], a[32:35], v[132:135], v[48:63]
    v_mfma_f32_32x32x16_bf16 v[80:95], a[36:39], v[132:135], v[80:95]
    buffer_load_dwordx4 v[188:191], v2, s[40:43], s75 offen offset:2048 sc1
    s_waitcnt vmcnt(13)
    v_mfma_f32_32x32x16_bf16 v[32:47], a[88:91], v[136:139], v[32:47]
    v_mfma_f32_32x32x16_bf16 v[64:79], a[92:95], v[136:139], v[64:79]
    buffer_load_dwordx4 v[192:195], v2, s[40:43], s77 offen offset:1024 sc1
    s_waitcnt vmcnt(13)
    v_mfma_f32_32x32x16_bf16 v[48:63], a[88:91], v[140:143], v[48:63]
    v_mfma_f32_32x32x16_bf16 v[80:95], a[92:95], v[140:143], v[80:95]
    buffer_load_dwordx4 v[196:199], v2, s[40:43], s79 offen offset:0 sc1
    s_waitcnt vmcnt(13)
    v_mfma_f32_32x32x16_bf16 v[32:47], a[144:147], v[144:147], v[32:47]
    v_mfma_f32_32x32x16_bf16 v[64:79], a[148:151], v[144:147], v[64:79]
    buffer_load_dwordx4 v[200:203], v2, s[40:43], s80 offen offset:3072 sc1
    s_waitcnt vmcnt(13)
    v_mfma_f32_32x32x16_bf16 v[48:63], a[144:147], v[148:151], v[48:63]
    v_mfma_f32_32x32x16_bf16 v[80:95], a[148:151], v[148:151], v[80:95]
    buffer_load_dwordx4 v[204:207], v2, s[40:43], s30 offen offset:2048 sc1
    s_waitcnt vmcnt(13)
    v_mfma_f32_32x32x16_bf16 v[32:47], a[200:203], v[152:155], v[32:47]
    v_mfma_f32_32x32x16_bf16 v[64:79], a[204:207], v[152:155], v[64:79]
    buffer_load_dwordx4 v[208:211], v2, s[40:43], s25 offen offset:2048 sc1
    s_waitcnt vmcnt(13)
    v_mfma_f32_32x32x16_bf16 v[48:63], a[200:203], v[156:159], v[48:63]
    v_mfma_f32_32x32x16_bf16 v[80:95], a[204:207], v[156:159], v[80:95]
    buffer_load_dwordx4 v[212:215], v2, s[40:43], s27 offen offset:1024 sc1
    s_waitcnt vmcnt(13)
    v_mfma_f32_32x32x16_bf16 v[32:47], a[40:43], v[160:163], v[32:47]
    v_mfma_f32_32x32x16_bf16 v[64:79], a[44:47], v[160:163], v[64:79]
    buffer_load_dwordx4 v[216:219], v2, s[40:43], s29 offen offset:0 sc1
    s_waitcnt vmcnt(13)
    v_mfma_f32_32x32x16_bf16 v[48:63], a[40:43], v[164:167], v[48:63]
    v_mfma_f32_32x32x16_bf16 v[80:95], a[44:47], v[164:167], v[80:95]
    buffer_load_dwordx4 v[220:223], v2, s[40:43], s30 offen offset:3072 sc1
    s_waitcnt vmcnt(13)
    v_mfma_f32_32x32x16_bf16 v[32:47], a[96:99], v[168:171], v[32:47]
    v_mfma_f32_32x32x16_bf16 v[64:79], a[100:103], v[168:171], v[64:79]
    buffer_load_dword v8, v5, s[40:43], s18 offen sc1
    s_add_u32 s18, s18, 8448
    s_waitcnt vmcnt(13)
    v_mfma_f32_32x32x16_bf16 v[48:63], a[96:99], v[172:175], v[48:63]
    v_mfma_f32_32x32x16_bf16 v[80:95], a[100:103], v[172:175], v[80:95]
    buffer_load_dword v9, v5, s[40:43], s18 offen sc1
    s_add_u32 s18, s18, 8448
    s_waitcnt vmcnt(13)
    v_mfma_f32_32x32x16_bf16 v[32:47], a[152:155], v[176:179], v[32:47]
    v_mfma_f32_32x32x16_bf16 v[64:79], a[156:159], v[176:179], v[64:79]
    buffer_load_dword v10, v5, s[40:43], s18 offen sc1
    s_add_u32 s18, s18, 8448
    s_waitcnt vmcnt(13)
    v_mfma_f32_32x32x16_bf16 v[48:63], a[152:155], v[180:183], v[48:63]
    v_mfma_f32_32x32x16_bf16 v[80:95], a[156:159], v[180:183], v[80:95]
    buffer_load_dword v11, v5, s[40:43], s18 offen sc1
    s_add_u32 s18, s18, 42240
    s_waitcnt vmcnt(13)
    v_mfma_f32_32x32x16_bf16 v[48:63], a[208:211], v[184:187], v[48:63]
    v_mfma_f32_32x32x16_bf16 v[80:95], a[212:215], v[184:187], v[80:95]
    buffer_load_dword v12, v5, s[40:43], s18 offen sc1
    s_add_u32 s18, s18, 8448
    s_waitcnt vmcnt(13)
    v_mfma_f32_32x32x16_bf16 v[48:63], a[48:51], v[188:191], v[48:63]
    v_mfma_f32_32x32x16_bf16 v[80:95], a[52:55], v[188:191], v[80:95]
    buffer_load_dword v13, v5, s[40:43], s18 offen sc1
    s_add_u32 s18, s18, 8448
    s_waitcnt vmcnt(13)
    v_mfma_f32_32x32x16_bf16 v[48:63], a[104:107], v[192:195], v[48:63]
    v_mfma_f32_32x32x16_bf16 v[80:95], a[108:111], v[192:195], v[80:95]
    buffer_load_dword v14, v5, s[40:43], s18 offen sc1
    s_add_u32 s18, s18, 8448
    s_waitcnt vmcnt(13)
    v_mfma_f32_32x32x16_bf16 v[48:63], a[160:163], v[196:199], v[48:63]
    v_mfma_f32_32x32x16_bf16 v[80:95], a[164:167], v[196:199], v[80:95]
    buffer_load_dword v15, v5, s[40:43], s18 offen sc1
    s_waitcnt vmcnt(13)
    v_mfma_f32_32x32x16_bf16 v[48:63], a[216:219], v[200:203], v[48:63]
    v_mfma_f32_32x32x16_bf16 v[80:95], a[220:223], v[200:203], v[80:95]
    s_waitcnt vmcnt(12)
    v_mfma_f32_32x32x16_bf16 v[32:47], a[208:211], v[204:207], v[32:47]
    s_nop 8
    ds_write_b128 v97, v[48:51] offset:0
    v_mfma_f32_32x32x16_bf16 v[64:79], a[212:215], v[204:207], v[64:79]
    ds_write_b128 v97, v[52:55] offset:1024
    s_waitcnt vmcnt(11)
    v_mfma_f32_32x32x16_bf16 v[32:47], a[48:51], v[208:211], v[32:47]
    ds_write_b128 v97, v[56:59] offset:2048
    v_mfma_f32_32x32x16_bf16 v[64:79], a[52:55], v[208:211], v[64:79]
    ds_write_b128 v97, v[60:63] offset:3072
    s_waitcnt vmcnt(10)
    v_mfma_f32_32x32x16_bf16 v[32:47], a[104:107], v[212:215], v[32:47]
    ds_write_b128 v99, v[80:83] offset:0
    v_mfma_f32_32x32x16_bf16 v[64:79], a[108:111], v[212:215], v[64:79]
    ds_write_b128 v99, v[84:87] offset:1024
    s_waitcnt vmcnt(9)
    v_mfma_f32_32x32x16_bf16 v[64:79], a[164:167], v[216:219], v[64:79]
    ds_write_b128 v99, v[88:91] offset:2048
    s_waitcnt vmcnt(8)
    v_mfma_f32_32x32x16_bf16 v[64:79], a[220:223], v[220:223], v[64:79]
    ds_write_b128 v99, v[92:95] offset:3072
    s_nop 10
    ds_write_b128 v98, v[64:67] offset:0
    v_mfma_f32_32x32x16_bf16 v[32:47], a[160:163], v[216:219], v[32:47]
    ds_write_b128 v98, v[68:71] offset:1024
    v_mfma_f32_32x32x16_bf16 v[32:47], a[216:219], v[220:223], v[32:47]
    ds_write_b128 v98, v[72:75] offset:2048
    ds_write_b128 v98, v[76:79] offset:3072
    s_waitcnt lgkmcnt(0)
    s_barrier
    ds_read_b128 v[128:131], v96 offset:0
    ds_read_b128 v[144:147], v96 offset:4096
    ds_read_b128 v[160:163], v96 offset:8192
    ds_read_b128 v[136:139], v96 offset:2048
    ds_read_b128 v[152:155], v96 offset:6144
    ds_read_b128 v[168:171], v96 offset:10240
    ds_read_b128 v[132:135], v96 offset:1024
    ds_read_b128 v[148:151], v96 offset:5120
    ds_read_b128 v[164:167], v96 offset:9216
    ds_read_b128 v[140:143], v96 offset:3072
    ds_read_b128 v[156:159], v96 offset:7168
    ds_read_b128 v[172:175], v96 offset:11264
    s_waitcnt vmcnt(0)
    s_waitcnt lgkmcnt(9)
    v_pk_add_f32 v[128:129], v[128:129], v[144:145]
    v_pk_add_f32 v[32:33], v[32:33], v[160:161]
    v_pk_add_f32 v[130:131], v[130:131], v[146:147]
    v_pk_add_f32 v[34:35], v[34:35], v[162:163]
    v_pk_add_f32 v[32:33], v[32:33], v[128:129]
    v_pk_add_f32 v[34:35], v[34:35], v[130:131]
    s_waitcnt lgkmcnt(6)
    v_pk_add_f32 v[136:137], v[136:137], v[152:153]
    v_pk_add_f32 v[40:41], v[40:41], v[168:169]
    v_pk_add_f32 v[138:139], v[138:139], v[154:155]
    v_pk_add_f32 v[42:43], v[42:43], v[170:171]
    v_pk_add_f32 v[40:41], v[40:41], v[136:137]
    v_pk_add_f32 v[42:43], v[42:43], v[138:139]
    v_lshlrev_b32 v176, 16, v8
    v_and_b32 v8, s87, v8
    v_lshlrev_b32 v177, 16, v9
    v_and_b32 v9, s87, v9
    v_lshlrev_b32 v178, 16, v10
    v_and_b32 v10, s87, v10
    v_lshlrev_b32 v179, 16, v11
    v_and_b32 v11, s87, v11
    v_fma_f32 v176, v16, v32, v176
    v_fma_f32 v8, v17, v40, v8
    v_fma_f32 v177, v18, v33, v177
    v_fma_f32 v9, v19, v41, v9
    v_fma_f32 v178, v20, v34, v178
    v_fma_f32 v10, v21, v42, v10
    v_fma_f32 v179, v22, v35, v179
    v_fma_f32 v11, v23, v43, v11
    v_cvt_pk_bf16_f32 v8, v176, v8
    v_cvt_pk_bf16_f32 v9, v177, v9
    v_cvt_pk_bf16_f32 v10, v178, v10
    v_cvt_pk_bf16_f32 v11, v179, v11
    ds_write_b128 v101, v[8:11]
    s_waitcnt lgkmcnt(4)
    v_pk_add_f32 v[132:133], v[132:133], v[148:149]
    v_pk_add_f32 v[36:37], v[36:37], v[164:165]
    v_pk_add_f32 v[134:135], v[134:135], v[150:151]
    v_pk_add_f32 v[38:39], v[38:39], v[166:167]
    v_pk_add_f32 v[36:37], v[36:37], v[132:133]
    v_pk_add_f32 v[38:39], v[38:39], v[134:135]
    s_waitcnt lgkmcnt(1)
    v_pk_add_f32 v[140:141], v[140:141], v[156:157]
    v_pk_add_f32 v[44:45], v[44:45], v[172:173]
    v_pk_add_f32 v[142:143], v[142:143], v[158:159]
    v_pk_add_f32 v[46:47], v[46:47], v[174:175]
    v_pk_add_f32 v[44:45], v[44:45], v[140:141]
    v_pk_add_f32 v[46:47], v[46:47], v[142:143]
    v_lshlrev_b32 v176, 16, v12
    v_and_b32 v12, s87, v12
    v_lshlrev_b32 v177, 16, v13
    v_and_b32 v13, s87, v13
    v_lshlrev_b32 v178, 16, v14
    v_and_b32 v14, s87, v14
    v_lshlrev_b32 v179, 16, v15
    v_and_b32 v15, s87, v15
    v_fma_f32 v176, v24, v36, v176
    v_fma_f32 v12, v25, v44, v12
    v_fma_f32 v177, v26, v37, v177
    v_fma_f32 v13, v27, v45, v13
    v_fma_f32 v178, v28, v38, v178
    v_fma_f32 v14, v29, v46, v14
    v_fma_f32 v179, v30, v39, v179
    v_fma_f32 v15, v31, v47, v15
    v_cvt_pk_bf16_f32 v12, v176, v12
    v_cvt_pk_bf16_f32 v13, v177, v13
    v_cvt_pk_bf16_f32 v14, v178, v14
    v_cvt_pk_bf16_f32 v15, v179, v15
    ds_write_b128 v102, v[12:15]
    ds_read_b128 v[128:131], v103 offset:0
    ds_read_b128 v[132:135], v103 offset:1024
    s_waitcnt lgkmcnt(1)
    buffer_store_dwordx4 v[128:131], v6, s[60:63], s8 offen sc1
    s_waitcnt lgkmcnt(0)
    buffer_store_dwordx4 v[132:135], v6, s[60:63], s9 offen sc1
    s_endpgm
Lend:
    s_endpgm
.section .rodata,"a"
.p2align 6
.amdhsa_kernel adaLN_cond__ssm_conv_s4d__swiglu_ffn__prompt_kernel
  .amdhsa_next_free_vgpr 512
  .amdhsa_next_free_sgpr 102
  .amdhsa_accum_offset 256
  .amdhsa_group_segment_fixed_size 0
  .amdhsa_kernarg_size 128
  .amdhsa_user_sgpr_count 2
  .amdhsa_user_sgpr_kernarg_segment_ptr 1
  .amdhsa_system_sgpr_workgroup_id_x 1
.end_amdhsa_kernel
```
